```python
import torch

def _softmax(x, axis=-1):
    return torch.softmax(x, dim=axis)
def _gelu(x):
    return torch.nn.functional.gelu(x, approximate="tanh")
def _silu(x):
    return torch.nn.functional.silu(x)
def _sigmoid(x):
    return torch.sigmoid(x)
def _layernorm(x, axis=-1, eps=1e-5):
    m = x.mean(dim=axis, keepdim=True)
    v = x.var(dim=axis, keepdim=True, unbiased=False)
    return (x - m) / torch.sqrt(v + eps)
def _scatter_add(tgt, idx, src, axis=0):
    return tgt.clone().index_add_(axis, idx, src)
def _segment_sum(src, seg, n):
    out = torch.zeros((n,) + src.shape[1:], dtype=src.dtype)
    return out.index_add_(0, seg, src)
def _pad(x, pw):
    flat = tuple(v for pair in reversed(pw) for v in pair)
    return torch.nn.functional.pad(x, flat)

kernel_name = 'concat_heads__gqa_block_cached__gqa_block_cached__decode'

def setup_inputs():

    _w = (lambda a: (lambda t: t.to(torch.bfloat16) if t.is_floating_point() else t)(torch.as_tensor(a)))
    def _A_setup():
        B, Sq, D = 2, 1, 640
        Hq, Hkv, Sk, Dh = 32, 32, 4096, 128
        assert Hq % Hkv == 0, (Hq, Hkv)
        return {
            "x": _w((lambda *s: torch.randn(*s, dtype=torch.bfloat16) * 0.8)(B, Sq, D)),
            "k_cache": _w((lambda *s: torch.randn(*s, dtype=torch.bfloat16) * 0.8)(B, Hkv, Sk, Dh)),
            "v_cache": _w((lambda *s: torch.randn(*s, dtype=torch.bfloat16) * 0.05)(B, Hkv, Sk, Dh)),
            "wq": _w((lambda *s: torch.randn(*s, dtype=torch.bfloat16) * 0.8)(D, Hq * Dh) * (D ** -0.5)),
            "wo": _w((lambda *s: torch.randn(*s, dtype=torch.bfloat16) * 0.05)(Hq * Dh, D) * ((Hq * Dh) ** -0.5)),
        }
    _A_in = _A_setup()

    def _B_setup():
        B, Sq, D = 2, 1, 640
        Hq, Hkv, Sk, Dh = 32, 32, 4096, 128
        assert Hq % Hkv == 0, (Hq, Hkv)
        return {
            "x": _w((lambda *s: torch.randn(*s, dtype=torch.bfloat16) * 0.8)(B, Sq, D)),
            "k_cache": _w((lambda *s: torch.randn(*s, dtype=torch.bfloat16) * 0.8)(B, Hkv, Sk, Dh)),
            "v_cache": _w((lambda *s: torch.randn(*s, dtype=torch.bfloat16) * 0.05)(B, Hkv, Sk, Dh)),
            "wq": _w((lambda *s: torch.randn(*s, dtype=torch.bfloat16) * 0.8)(D, Hq * Dh) * (D ** -0.5)),
            "wo": _w((lambda *s: torch.randn(*s, dtype=torch.bfloat16) * 0.05)(Hq * Dh, D) * ((Hq * Dh) ** -0.5)),
        }
    _B_in = _B_setup()

    return {
        "A_x": _A_in["x"],
        "A_k_cache": _A_in["k_cache"],
        "A_v_cache": _A_in["v_cache"],
        "A_wq": _A_in["wq"],
        "A_wo": _A_in["wo"],
        "B_x": _B_in["x"],
        "B_k_cache": _B_in["k_cache"],
        "B_v_cache": _B_in["v_cache"],
        "B_wq": _B_in["wq"],
        "B_wo": _B_in["wo"],
    }

def reference(A_x, A_k_cache, A_v_cache, A_wq, A_wo, B_x, B_k_cache, B_v_cache, B_wq, B_wo):
    def _A_ref(x, k_cache, v_cache, wq, wo):
        B, Sq, D = x.shape
        Hq, Dh = 32, 128
        Hkv = k_cache.shape[1]
        rep = Hq // Hkv
        q = (lambda x, *d: x.permute(*d))((x @ wq).reshape(B, Sq, Hq, Dh), 0, 2, 1, 3)
        k = (lambda x, n, axis: torch.repeat_interleave(x, n, dim=axis))(k_cache, rep, axis=1)
        v = (lambda x, n, axis: torch.repeat_interleave(x, n, dim=axis))(v_cache, rep, axis=1)
        scores = torch.einsum("bhqd,bhkd->bhqk", q, k) * (Dh ** -0.5)
        p = _softmax(scores, axis=-1)
        o = torch.einsum("bhqk,bhkd->bhqd", p, v)
        return (lambda x, *d: x.permute(*d))(o, 0, 2, 1, 3).reshape(B, Sq, Hq * Dh) @ wo

    def _B_ref(x, k_cache, v_cache, wq, wo):
        B, Sq, D = x.shape
        Hq, Dh = 32, 128
        Hkv = k_cache.shape[1]
        rep = Hq // Hkv
        q = (lambda x, *d: x.permute(*d))((x @ wq).reshape(B, Sq, Hq, Dh), 0, 2, 1, 3)
        k = (lambda x, n, axis: torch.repeat_interleave(x, n, dim=axis))(k_cache, rep, axis=1)
        v = (lambda x, n, axis: torch.repeat_interleave(x, n, dim=axis))(v_cache, rep, axis=1)
        scores = torch.einsum("bhqd,bhkd->bhqk", q, k) * (Dh ** -0.5)
        p = _softmax(scores, axis=-1)
        o = torch.einsum("bhqk,bhkd->bhqd", p, v)
        return (lambda x, *d: x.permute(*d))(o, 0, 2, 1, 3).reshape(B, Sq, Hq * Dh) @ wo

    a = _A_ref(A_x, A_k_cache, A_v_cache, A_wq, A_wo)
    b = _B_ref(B_x, B_k_cache, B_v_cache, B_wq, B_wo)
    return torch.concatenate([a, b], axis=-1)
```

```asm
; @launch grid=(256,1,1) block=(512,1,1) lds=31040
.amdgcn_target "amdgcn-amd-amdhsa--gfx950"
.text
.globl concat_heads__gqa_block_cached__gqa_block_cached__decode_kernel
.p2align 8
.type concat_heads__gqa_block_cached__gqa_block_cached__decode_kernel,@function
concat_heads__gqa_block_cached__gqa_block_cached__decode_kernel:
    s_cmp_ge_u32 s2, 256
    s_cbranch_scc1 L_exit
    s_and_b32 s57, s2, 7
    s_and_b32 s26, s2, 1
    s_lshr_b32 s57, s57, 1
    s_mul_i32 s60, s26, 40
    s_add_u32 s4, s0, s60
    s_addc_u32 s5, s1, 0
    s_load_dwordx8 s[8:15], s[4:5], 0
    s_load_dwordx2 s[16:17], s[4:5], 32
    s_load_dwordx4 s[20:23], s[0:1], 80
    s_load_dwordx2 s[24:25], s[0:1], 96
    s_lshr_b32 s58, s2, 3
    s_lshl_b32 s57, s57, 3
    s_lshr_b32 s59, s58, 2
    s_add_u32 s57, s57, s59
    s_and_b32 s27, s57, 31
    s_lshr_b32 s28, s58, 1
    s_and_b32 s28, s28, 1
    s_and_b32 s29, s58, 1
    v_and_b32 v1, 63, v0
    v_lshrrev_b32 v10, 6, v0
    v_and_b32 v2, 15, v0
    v_readfirstlane_b32 s30, v10
    v_lshrrev_b32 v3, 4, v1
    s_lshl_b32 s69, s26, 1
    s_add_u32 s69, s69, s28
    s_lshl_b32 s31, s69, 5
    s_add_u32 s31, s31, s27
    s_lshl_b32 s31, s31, 1
    s_add_u32 s31, s31, s29
    v_lshlrev_b32 v4, 4, v1
    s_mul_i32 s57, s29, 16384
    s_bfe_u32 s58, s30, 0x10000
    s_mul_i32 s58, s58, 4096
    s_xor_b32 s57, s57, s58
    s_bfe_u32 s58, s30, 0x10001
    s_mul_i32 s58, s58, 8192
    s_xor_b32 s57, s57, s58
    s_bfe_u32 s58, s30, 0x10002
    s_mul_i32 s58, s58, 32768
    s_xor_b32 s57, s57, s58
    v_add_u32 v4, s57, v4
    v_xor_b32 v15, 16384, v4
    s_mul_i32 s57, s30, 80
    v_add_u32 v5, s57, v3
    v_lshlrev_b32 v5, 13, v5
    v_lshl_add_u32 v5, v2, 4, v5
    s_mov_b32 s34, 1048576
    s_mov_b32 s35, 0x20000
    s_lshl_b32 s57, s27, 8
    s_sub_u32 s42, 5242880, s57
    s_mov_b32 s43, 0x20000
    s_bfe_u32 s58, s31, 0x60001
    s_lshl_b32 s58, s58, 20
    s_waitcnt lgkmcnt(0)
    s_add_u32 s40, s14, s57
    s_addc_u32 s41, s15, 0
    s_add_u32 s32, s10, s58
    s_addc_u32 s33, s11, 0
    buffer_load_dwordx4 v[168:171], v5, s[40:43], 0 offen nt
    s_mov_b32 s56, 32768
    buffer_load_dwordx4 v[172:175], v5, s[40:43], s56 offen nt
    s_mov_b32 s56, 65536
    buffer_load_dwordx4 v[176:179], v5, s[40:43], s56 offen nt
    s_mov_b32 s56, 98304
    buffer_load_dwordx4 v[180:183], v5, s[40:43], s56 offen nt
    buffer_load_dwordx4 v[56:59], v4, s[32:35], 0 offen nt
    buffer_load_dwordx4 v[60:63], v4, s[32:35], 0 offen offset:1024 nt
    buffer_load_dwordx4 v[64:67], v4, s[32:35], 0 offen offset:2048 nt
    buffer_load_dwordx4 v[68:71], v4, s[32:35], 0 offen offset:3072 nt
    s_mov_b32 s50, 1280
    s_mov_b32 s51, 0x20000
    s_mov_b32 s38, 1048576
    s_mov_b32 s39, 0x20000
    s_mov_b32 s46, 163840
    s_mov_b32 s47, 0x20000
    s_mov_b32 s54, 8388608
    s_mov_b32 s55, 0x20000
    s_mov_b32 s78, 5120
    s_mov_b32 s79, 0x20000
    s_mul_i32 s59, s28, 1280
    s_mul_i32 s60, s27, 163840
    s_mul_i32 s57, s30, 80
    v_lshl_add_u32 v7, v2, 2, v3
    v_add_u32 v7, s57, v7
    v_lshlrev_b32 v7, 1, v7
    v_add_u32 v9, 128, v7
    s_mul_i32 s57, s30, 16
    v_add_u32 v6, s57, v3
    v_mul_u32_u24 v6, 1280, v6
    v_lshl_add_u32 v6, v2, 4, v6
    s_add_u32 s48, s8, s59
    s_addc_u32 s49, s9, 0
    buffer_load_ushort v8, v7, s[48:51], 0 offen nt
    buffer_load_ushort v9, v9, s[48:51], 0 offen nt
    s_add_u32 s36, s12, s58
    s_addc_u32 s37, s13, 0
    s_add_u32 s44, s16, s60
    s_addc_u32 s45, s17, 0
    s_mov_b32 s52, s24
    s_mov_b32 s53, s25
    s_mov_b32 s76, s20
    s_mov_b32 s77, s21
    s_and_b32 s57, s31, 63
    s_cmp_lg_u32 s57, 0
    s_cbranch_scc1 L_nozero_1
    s_cmp_lg_u32 s30, 0
    s_cbranch_scc1 L_nozero_1
    v_mov_b32 v48, 0
    v_mov_b32 v49, 0
    v_mov_b32 v50, 0
    v_mov_b32 v51, 0
    v_lshlrev_b32 v52, 4, v1
    s_lshl_b32 s57, s69, 12
    buffer_store_dwordx4 v[48:51], v52, s[52:55], s57 offen offset:0 sc1
    buffer_store_dwordx4 v[48:51], v52, s[52:55], s57 offen offset:1024 sc1
    buffer_store_dwordx4 v[48:51], v52, s[52:55], s57 offen offset:2048 sc1
    buffer_store_dwordx4 v[48:51], v52, s[52:55], s57 offen offset:3072 sc1
    v_lshlrev_b32 v52, 7, v1
    s_lshl_b32 s57, s69, 13
    s_add_u32 s57, s57, 65536
    buffer_store_dword v48, v52, s[52:55], s57 offen sc1
    s_cmp_lg_u32 s69, 0
    s_cbranch_scc1 L_nozero_1
    v_lshlrev_b32 v52, 8, v1
    s_mov_b32 s57, 131072
    buffer_store_dword v48, v52, s[52:55], s57 offen sc1
    s_mov_b32 s57, 147456
    buffer_store_dword v48, v52, s[52:55], s57 offen sc1
    s_mov_b32 s57, 163840
    buffer_store_dword v48, v52, s[52:55], s57 offen sc1
    s_mov_b32 s57, 180224
    buffer_store_dword v48, v52, s[52:55], s57 offen sc1
L_nozero_1:
    s_mov_b32 s56, 131072
    buffer_load_dwordx4 v[184:187], v5, s[40:43], s56 offen nt
    s_mov_b32 s56, 163840
    buffer_load_dwordx4 v[188:191], v5, s[40:43], s56 offen nt
    s_mov_b32 s56, 196608
    buffer_load_dwordx4 v[192:195], v5, s[40:43], s56 offen nt
    s_mov_b32 s56, 229376
    buffer_load_dwordx4 v[196:199], v5, s[40:43], s56 offen nt
    s_mov_b32 s56, 65536
    buffer_load_dwordx4 v[72:75], v4, s[32:35], s56 offen nt
    buffer_load_dwordx4 v[76:79], v4, s[32:35], s56 offen offset:1024 nt
    buffer_load_dwordx4 v[80:83], v4, s[32:35], s56 offen offset:2048 nt
    buffer_load_dwordx4 v[84:87], v4, s[32:35], s56 offen offset:3072 nt
    s_mov_b32 s56, 262144
    buffer_load_dwordx4 v[200:203], v5, s[40:43], s56 offen nt
    s_mov_b32 s56, 294912
    buffer_load_dwordx4 v[204:207], v5, s[40:43], s56 offen nt
    s_mov_b32 s56, 327680
    buffer_load_dwordx4 v[208:211], v5, s[40:43], s56 offen nt
    s_mov_b32 s56, 360448
    buffer_load_dwordx4 v[212:215], v5, s[40:43], s56 offen nt
    s_mov_b32 s56, 262144
    buffer_load_dwordx4 v[88:91], v4, s[32:35], s56 offen nt
    buffer_load_dwordx4 v[92:95], v4, s[32:35], s56 offen offset:1024 nt
    buffer_load_dwordx4 v[96:99], v4, s[32:35], s56 offen offset:2048 nt
    buffer_load_dwordx4 v[100:103], v4, s[32:35], s56 offen offset:3072 nt
    s_mov_b32 s56, 393216
    buffer_load_dwordx4 v[216:219], v5, s[40:43], s56 offen nt
    s_mov_b32 s56, 425984
    buffer_load_dwordx4 v[220:223], v5, s[40:43], s56 offen nt
    s_mov_b32 s56, 458752
    buffer_load_dwordx4 v[224:227], v5, s[40:43], s56 offen nt
    s_mov_b32 s56, 491520
    buffer_load_dwordx4 v[228:231], v5, s[40:43], s56 offen nt
    s_mov_b32 s56, 327680
    buffer_load_dwordx4 v[104:107], v4, s[32:35], s56 offen nt
    buffer_load_dwordx4 v[108:111], v4, s[32:35], s56 offen offset:1024 nt
    buffer_load_dwordx4 v[112:115], v4, s[32:35], s56 offen offset:2048 nt
    buffer_load_dwordx4 v[116:119], v4, s[32:35], s56 offen offset:3072 nt
    s_mov_b32 s56, 524288
    buffer_load_dwordx4 v[232:235], v5, s[40:43], s56 offen nt
    s_mov_b32 s56, 557056
    buffer_load_dwordx4 v[236:239], v5, s[40:43], s56 offen nt
    s_mov_b32 s56, 589824
    buffer_load_dwordx4 v[240:243], v5, s[40:43], s56 offen nt
    s_mov_b32 s56, 622592
    buffer_load_dwordx4 v[244:247], v5, s[40:43], s56 offen nt
    s_mov_b32 s56, 524288
    buffer_load_dwordx4 v[120:123], v15, s[32:35], s56 offen nt
    buffer_load_dwordx4 v[124:127], v15, s[32:35], s56 offen offset:1024 nt
    buffer_load_dwordx4 v[128:131], v15, s[32:35], s56 offen offset:2048 nt
    buffer_load_dwordx4 v[132:135], v15, s[32:35], s56 offen offset:3072 nt
    v_and_b32 v10, 1, v2
    v_lshlrev_b32 v10, 4, v10
    v_mov_b32 v11, 0xffff
    v_lshlrev_b32 v11, v10, v11
    v_lshrrev_b32 v12, 1, v2
    v_cmp_eq_u32 vcc, 0, v12
    s_nop 1
    v_cndmask_b32 v20, 0, v11, vcc
    v_cmp_eq_u32 vcc, 1, v12
    s_nop 1
    v_cndmask_b32 v21, 0, v11, vcc
    v_cmp_eq_u32 vcc, 2, v12
    s_nop 1
    v_cndmask_b32 v22, 0, v11, vcc
    v_cmp_eq_u32 vcc, 3, v12
    s_nop 1
    v_cndmask_b32 v23, 0, v11, vcc
    s_mov_b32 s64, 0xcccccccc
    s_mov_b32 s65, 0xcccccccc
    s_mov_b32 s66, 0xaaaaaaaa
    s_mov_b32 s67, 0xaaaaaaaa
    s_mov_b32 s68, 0x3e0293ee
    v_lshlrev_b32 v10, 5, v2
    v_lshl_add_u32 v10, v3, 4, v10
    s_lshl_b32 s57, s30, 9
    v_add_u32 v11, s57, v10
    s_lshl_b32 s63, s69, 2
    s_lshl_b32 s62, s31, 7
    s_add_u32 s62, s62, 65536
    s_and_b32 s57, s2, 7
    s_mul_i32 s57, s57, 5
    s_lshr_b32 s61, s2, 3
    s_add_u32 s61, s61, s57
    s_and_b32 s61, s61, 31
    s_lshl_b32 s61, s61, 8
    s_add_u32 s61, s61, 131072
    s_mov_b32 s70, 0
    s_mov_b64 vcc, -1
    v_mov_b32 v14, 0
    v_mov_b32 v55, 1
    ds_write_b32 v14, v55 offset:30976
    s_waitcnt vmcnt(32)
    v_lshl_or_b32 v8, v8, 16, v8
    v_lshl_or_b32 v9, v9, 16, v9
    s_nop 1
    v_and_b32_dpp v32, v8, v20 row_newbcast:0 row_mask:0xf bank_mask:0xf
    v_and_b32_dpp v33, v8, v21 row_newbcast:0 row_mask:0xf bank_mask:0xf
    v_and_b32_dpp v34, v8, v22 row_newbcast:0 row_mask:0xf bank_mask:0xf
    v_and_b32_dpp v35, v8, v23 row_newbcast:0 row_mask:0xf bank_mask:0xf
    v_and_b32_dpp v36, v8, v20 row_newbcast:1 row_mask:0xf bank_mask:0xf
    v_and_b32_dpp v37, v8, v21 row_newbcast:1 row_mask:0xf bank_mask:0xf
    v_and_b32_dpp v38, v8, v22 row_newbcast:1 row_mask:0xf bank_mask:0xf
    v_and_b32_dpp v39, v8, v23 row_newbcast:1 row_mask:0xf bank_mask:0xf
    v_and_b32_dpp v40, v8, v20 row_newbcast:2 row_mask:0xf bank_mask:0xf
    v_and_b32_dpp v41, v8, v21 row_newbcast:2 row_mask:0xf bank_mask:0xf
    v_and_b32_dpp v42, v8, v22 row_newbcast:2 row_mask:0xf bank_mask:0xf
    v_and_b32_dpp v43, v8, v23 row_newbcast:2 row_mask:0xf bank_mask:0xf
    v_and_b32_dpp v44, v8, v20 row_newbcast:3 row_mask:0xf bank_mask:0xf
    v_and_b32_dpp v45, v8, v21 row_newbcast:3 row_mask:0xf bank_mask:0xf
    v_and_b32_dpp v46, v8, v22 row_newbcast:3 row_mask:0xf bank_mask:0xf
    v_and_b32_dpp v47, v8, v23 row_newbcast:3 row_mask:0xf bank_mask:0xf
    s_nop 1
    v_mfma_f32_16x16x32_bf16 v[24:27], v[32:35], v[168:171], 0
    v_mfma_f32_16x16x32_bf16 v[24:27], v[36:39], v[172:175], v[24:27]
    v_mfma_f32_16x16x32_bf16 v[24:27], v[40:43], v[176:179], v[24:27]
    v_mfma_f32_16x16x32_bf16 v[24:27], v[44:47], v[180:183], v[24:27]
    v_and_b32_dpp v32, v8, v20 row_newbcast:4 row_mask:0xf bank_mask:0xf
    v_and_b32_dpp v33, v8, v21 row_newbcast:4 row_mask:0xf bank_mask:0xf
    v_and_b32_dpp v34, v8, v22 row_newbcast:4 row_mask:0xf bank_mask:0xf
    v_and_b32_dpp v35, v8, v23 row_newbcast:4 row_mask:0xf bank_mask:0xf
    v_and_b32_dpp v36, v8, v20 row_newbcast:5 row_mask:0xf bank_mask:0xf
    v_and_b32_dpp v37, v8, v21 row_newbcast:5 row_mask:0xf bank_mask:0xf
    v_and_b32_dpp v38, v8, v22 row_newbcast:5 row_mask:0xf bank_mask:0xf
    v_and_b32_dpp v39, v8, v23 row_newbcast:5 row_mask:0xf bank_mask:0xf
    v_and_b32_dpp v40, v8, v20 row_newbcast:6 row_mask:0xf bank_mask:0xf
    v_and_b32_dpp v41, v8, v21 row_newbcast:6 row_mask:0xf bank_mask:0xf
    v_and_b32_dpp v42, v8, v22 row_newbcast:6 row_mask:0xf bank_mask:0xf
    v_and_b32_dpp v43, v8, v23 row_newbcast:6 row_mask:0xf bank_mask:0xf
    v_and_b32_dpp v44, v8, v20 row_newbcast:7 row_mask:0xf bank_mask:0xf
    v_and_b32_dpp v45, v8, v21 row_newbcast:7 row_mask:0xf bank_mask:0xf
    v_and_b32_dpp v46, v8, v22 row_newbcast:7 row_mask:0xf bank_mask:0xf
    v_and_b32_dpp v47, v8, v23 row_newbcast:7 row_mask:0xf bank_mask:0xf
    s_waitcnt vmcnt(28)
    s_nop 1
    v_mfma_f32_16x16x32_bf16 v[24:27], v[32:35], v[184:187], v[24:27]
    v_mfma_f32_16x16x32_bf16 v[24:27], v[36:39], v[188:191], v[24:27]
    v_mfma_f32_16x16x32_bf16 v[24:27], v[40:43], v[192:195], v[24:27]
    v_mfma_f32_16x16x32_bf16 v[24:27], v[44:47], v[196:199], v[24:27]
    v_and_b32_dpp v32, v8, v20 row_newbcast:8 row_mask:0xf bank_mask:0xf
    v_and_b32_dpp v33, v8, v21 row_newbcast:8 row_mask:0xf bank_mask:0xf
    v_and_b32_dpp v34, v8, v22 row_newbcast:8 row_mask:0xf bank_mask:0xf
    v_and_b32_dpp v35, v8, v23 row_newbcast:8 row_mask:0xf bank_mask:0xf
    v_and_b32_dpp v36, v8, v20 row_newbcast:9 row_mask:0xf bank_mask:0xf
    v_and_b32_dpp v37, v8, v21 row_newbcast:9 row_mask:0xf bank_mask:0xf
    v_and_b32_dpp v38, v8, v22 row_newbcast:9 row_mask:0xf bank_mask:0xf
    v_and_b32_dpp v39, v8, v23 row_newbcast:9 row_mask:0xf bank_mask:0xf
    v_and_b32_dpp v40, v8, v20 row_newbcast:10 row_mask:0xf bank_mask:0xf
    v_and_b32_dpp v41, v8, v21 row_newbcast:10 row_mask:0xf bank_mask:0xf
    v_and_b32_dpp v42, v8, v22 row_newbcast:10 row_mask:0xf bank_mask:0xf
    v_and_b32_dpp v43, v8, v23 row_newbcast:10 row_mask:0xf bank_mask:0xf
    v_and_b32_dpp v44, v8, v20 row_newbcast:11 row_mask:0xf bank_mask:0xf
    v_and_b32_dpp v45, v8, v21 row_newbcast:11 row_mask:0xf bank_mask:0xf
    v_and_b32_dpp v46, v8, v22 row_newbcast:11 row_mask:0xf bank_mask:0xf
    v_and_b32_dpp v47, v8, v23 row_newbcast:11 row_mask:0xf bank_mask:0xf
    s_waitcnt vmcnt(20)
    s_nop 1
    v_mfma_f32_16x16x32_bf16 v[24:27], v[32:35], v[200:203], v[24:27]
    v_mfma_f32_16x16x32_bf16 v[24:27], v[36:39], v[204:207], v[24:27]
    v_mfma_f32_16x16x32_bf16 v[24:27], v[40:43], v[208:211], v[24:27]
    v_mfma_f32_16x16x32_bf16 v[24:27], v[44:47], v[212:215], v[24:27]
    v_and_b32_dpp v32, v8, v20 row_newbcast:12 row_mask:0xf bank_mask:0xf
    v_and_b32_dpp v33, v8, v21 row_newbcast:12 row_mask:0xf bank_mask:0xf
    v_and_b32_dpp v34, v8, v22 row_newbcast:12 row_mask:0xf bank_mask:0xf
    v_and_b32_dpp v35, v8, v23 row_newbcast:12 row_mask:0xf bank_mask:0xf
    v_and_b32_dpp v36, v8, v20 row_newbcast:13 row_mask:0xf bank_mask:0xf
    v_and_b32_dpp v37, v8, v21 row_newbcast:13 row_mask:0xf bank_mask:0xf
    v_and_b32_dpp v38, v8, v22 row_newbcast:13 row_mask:0xf bank_mask:0xf
    v_and_b32_dpp v39, v8, v23 row_newbcast:13 row_mask:0xf bank_mask:0xf
    v_and_b32_dpp v40, v8, v20 row_newbcast:14 row_mask:0xf bank_mask:0xf
    v_and_b32_dpp v41, v8, v21 row_newbcast:14 row_mask:0xf bank_mask:0xf
    v_and_b32_dpp v42, v8, v22 row_newbcast:14 row_mask:0xf bank_mask:0xf
    v_and_b32_dpp v43, v8, v23 row_newbcast:14 row_mask:0xf bank_mask:0xf
    v_and_b32_dpp v44, v8, v20 row_newbcast:15 row_mask:0xf bank_mask:0xf
    v_and_b32_dpp v45, v8, v21 row_newbcast:15 row_mask:0xf bank_mask:0xf
    v_and_b32_dpp v46, v8, v22 row_newbcast:15 row_mask:0xf bank_mask:0xf
    v_and_b32_dpp v47, v8, v23 row_newbcast:15 row_mask:0xf bank_mask:0xf
    s_waitcnt vmcnt(12)
    s_nop 1
    v_mfma_f32_16x16x32_bf16 v[24:27], v[32:35], v[216:219], v[24:27]
    v_mfma_f32_16x16x32_bf16 v[24:27], v[36:39], v[220:223], v[24:27]
    v_mfma_f32_16x16x32_bf16 v[24:27], v[40:43], v[224:227], v[24:27]
    v_mfma_f32_16x16x32_bf16 v[24:27], v[44:47], v[228:231], v[24:27]
    v_and_b32_dpp v32, v9, v20 row_newbcast:0 row_mask:0xf bank_mask:0xf
    v_and_b32_dpp v33, v9, v21 row_newbcast:0 row_mask:0xf bank_mask:0xf
    v_and_b32_dpp v34, v9, v22 row_newbcast:0 row_mask:0xf bank_mask:0xf
    v_and_b32_dpp v35, v9, v23 row_newbcast:0 row_mask:0xf bank_mask:0xf
    v_and_b32_dpp v36, v9, v20 row_newbcast:1 row_mask:0xf bank_mask:0xf
    v_and_b32_dpp v37, v9, v21 row_newbcast:1 row_mask:0xf bank_mask:0xf
    v_and_b32_dpp v38, v9, v22 row_newbcast:1 row_mask:0xf bank_mask:0xf
    v_and_b32_dpp v39, v9, v23 row_newbcast:1 row_mask:0xf bank_mask:0xf
    v_and_b32_dpp v40, v9, v20 row_newbcast:2 row_mask:0xf bank_mask:0xf
    v_and_b32_dpp v41, v9, v21 row_newbcast:2 row_mask:0xf bank_mask:0xf
    v_and_b32_dpp v42, v9, v22 row_newbcast:2 row_mask:0xf bank_mask:0xf
    v_and_b32_dpp v43, v9, v23 row_newbcast:2 row_mask:0xf bank_mask:0xf
    v_and_b32_dpp v44, v9, v20 row_newbcast:3 row_mask:0xf bank_mask:0xf
    v_and_b32_dpp v45, v9, v21 row_newbcast:3 row_mask:0xf bank_mask:0xf
    v_and_b32_dpp v46, v9, v22 row_newbcast:3 row_mask:0xf bank_mask:0xf
    v_and_b32_dpp v47, v9, v23 row_newbcast:3 row_mask:0xf bank_mask:0xf
    s_waitcnt vmcnt(4)
    s_nop 1
    v_mfma_f32_16x16x32_bf16 v[24:27], v[32:35], v[232:235], v[24:27]
    v_mfma_f32_16x16x32_bf16 v[24:27], v[36:39], v[236:239], v[24:27]
    v_mfma_f32_16x16x32_bf16 v[24:27], v[40:43], v[240:243], v[24:27]
    v_mfma_f32_16x16x32_bf16 v[24:27], v[44:47], v[244:247], v[24:27]
    s_cmp_lg_u32 s30, 0
    s_cbranch_scc1 L_zs_2
    s_and_b32 s57, s31, 63
    s_cmp_lg_u32 s57, 0
    s_cbranch_scc1 L_nz_3
    s_mov_b32 s19, 1
    s_atomic_or s19, s[22:23], s63 glc
L_nz_3:
L_zs_2:
    s_nop 7
    s_mov_b32 exec_hi, 0
    ds_write_b128 v11, v[24:27] offset:0
    s_mov_b64 exec, -1
    s_mov_b32 s56, 589824
    buffer_load_dwordx4 v[136:139], v15, s[32:35], s56 offen nt
    buffer_load_dwordx4 v[140:143], v15, s[32:35], s56 offen offset:1024 nt
    buffer_load_dwordx4 v[144:147], v15, s[32:35], s56 offen offset:2048 nt
    buffer_load_dwordx4 v[148:151], v15, s[32:35], s56 offen offset:3072 nt
    s_mov_b32 s56, 786432
    buffer_load_dwordx4 v[152:155], v15, s[32:35], s56 offen nt
    buffer_load_dwordx4 v[156:159], v15, s[32:35], s56 offen offset:1024 nt
    buffer_load_dwordx4 v[160:163], v15, s[32:35], s56 offen offset:2048 nt
    buffer_load_dwordx4 v[164:167], v15, s[32:35], s56 offen offset:3072 nt
    v_lshlrev_b32 v12, 3, v1
    s_waitcnt lgkmcnt(0)
    s_barrier
    ds_read_b64 v[32:33], v12 offset:0
    ds_read_b64 v[34:35], v12 offset:512
    ds_read_b64 v[36:37], v12 offset:1024
    ds_read_b64 v[38:39], v12 offset:1536
    ds_read_b64 v[40:41], v12 offset:2048
    ds_read_b64 v[42:43], v12 offset:2560
    ds_read_b64 v[44:45], v12 offset:3072
    ds_read_b64 v[46:47], v12 offset:3584
    s_lshl_b32 s57, s30, 8
    v_lshlrev_b32 v12, 2, v1
    v_add_u32 v12, s57, v12
    v_lshlrev_b32 v13, 4, v2
    v_add_u32 v13, s57, v13
    s_waitcnt lgkmcnt(0)
    v_add_f32 v32, v32, v34
    v_add_f32 v33, v33, v35
    v_add_f32 v32, v32, v36
    v_add_f32 v33, v33, v37
    v_add_f32 v32, v32, v38
    v_add_f32 v33, v33, v39
    v_add_f32 v32, v32, v40
    v_add_f32 v33, v33, v41
    v_add_f32 v32, v32, v42
    v_add_f32 v33, v33, v43
    v_add_f32 v32, v32, v44
    v_add_f32 v33, v33, v45
    v_add_f32 v32, v32, v46
    v_add_f32 v33, v33, v47
    v_cvt_pk_bf16_f32 v48, v32, v33
    ds_write_b32 v12, v48 offset:4096
    s_waitcnt lgkmcnt(0)
    ds_read_b128 v[16:19], v13 offset:4096
    s_waitcnt lgkmcnt(0)
    v_dot2_f32_bf16 v32, v56, v16, 0
    v_dot2_f32_bf16 v33, v60, v16, 0
    v_dot2_f32_bf16 v34, v64, v16, 0
    v_dot2_f32_bf16 v35, v68, v16, 0
    v_dot2_f32_bf16 v32, v57, v17, v32
    v_dot2_f32_bf16 v33, v61, v17, v33
    v_dot2_f32_bf16 v34, v65, v17, v34
    v_dot2_f32_bf16 v35, v69, v17, v35
    v_dot2_f32_bf16 v32, v58, v18, v32
    v_dot2_f32_bf16 v33, v62, v18, v33
    v_dot2_f32_bf16 v34, v66, v18, v34
    v_dot2_f32_bf16 v35, v70, v18, v35
    v_dot2_f32_bf16 v32, v59, v19, v32
    v_dot2_f32_bf16 v33, v63, v19, v33
    v_dot2_f32_bf16 v34, v67, v19, v34
    v_dot2_f32_bf16 v35, v71, v19, v35
    s_nop 2
    v_add_f32_dpp v32, v32, v32 row_ror:8 row_mask:0xf bank_mask:0x3
    v_add_f32_dpp v34, v34, v34 row_ror:8 row_mask:0xf bank_mask:0x3
    v_add_f32_dpp v32, v33, v33 row_ror:8 row_mask:0xf bank_mask:0xc
    v_add_f32_dpp v34, v35, v35 row_ror:8 row_mask:0xf bank_mask:0xc
    s_nop 1
    v_add_f32_dpp v36, v32, v32 row_half_mirror row_mask:0xf bank_mask:0x5
    v_add_f32_dpp v36, v34, v34 row_half_mirror row_mask:0xf bank_mask:0xa
    s_waitcnt vmcnt(3)
    buffer_load_dwordx4 v[168:171], v6, s[44:47], 0 offen nt
    s_mov_b32 s56, 851968
    buffer_load_dwordx4 v[56:59], v15, s[32:35], s56 offen nt
    s_waitcnt vmcnt(3)
    buffer_load_dwordx4 v[60:63], v15, s[32:35], s56 offen offset:1024 nt
    s_waitcnt vmcnt(3)
    buffer_load_dwordx4 v[172:175], v6, s[44:47], 0 offen offset:256 nt
    buffer_load_dwordx4 v[64:67], v15, s[32:35], s56 offen offset:2048 nt
    s_waitcnt vmcnt(3)
    buffer_load_dwordx4 v[68:71], v15, s[32:35], s56 offen offset:3072 nt
    v_dot2_f32_bf16 v32, v72, v16, 0
    v_dot2_f32_bf16 v33, v76, v16, 0
    v_dot2_f32_bf16 v34, v80, v16, 0
    v_dot2_f32_bf16 v35, v84, v16, 0
    v_dot2_f32_bf16 v32, v73, v17, v32
    v_dot2_f32_bf16 v33, v77, v17, v33
    v_dot2_f32_bf16 v34, v81, v17, v34
    v_dot2_f32_bf16 v35, v85, v17, v35
    v_dot2_f32_bf16 v32, v74, v18, v32
    v_dot2_f32_bf16 v33, v78, v18, v33
    v_dot2_f32_bf16 v34, v82, v18, v34
    v_dot2_f32_bf16 v35, v86, v18, v35
    v_dot2_f32_bf16 v32, v75, v19, v32
    v_dot2_f32_bf16 v33, v79, v19, v33
    v_dot2_f32_bf16 v34, v83, v19, v34
    v_dot2_f32_bf16 v35, v87, v19, v35
    s_nop 2
    v_add_f32_dpp v32, v32, v32 row_ror:8 row_mask:0xf bank_mask:0x3
    v_add_f32_dpp v34, v34, v34 row_ror:8 row_mask:0xf bank_mask:0x3
    v_add_f32_dpp v32, v33, v33 row_ror:8 row_mask:0xf bank_mask:0xc
    v_add_f32_dpp v34, v35, v35 row_ror:8 row_mask:0xf bank_mask:0xc
    s_nop 1
    v_add_f32_dpp v37, v32, v32 row_half_mirror row_mask:0xf bank_mask:0x5
    v_add_f32_dpp v37, v34, v34 row_half_mirror row_mask:0xf bank_mask:0xa
    s_barrier
    s_waitcnt vmcnt(3)
    buffer_load_dwordx4 v[176:179], v6, s[44:47], 0 offen offset:512 nt
    s_mov_b32 s56, 131072
    buffer_load_dwordx4 v[72:75], v4, s[32:35], s56 offen nt
    v_dot2_f32_bf16 v32, v88, v16, 0
    v_dot2_f32_bf16 v33, v92, v16, 0
    v_dot2_f32_bf16 v34, v96, v16, 0
    v_dot2_f32_bf16 v35, v100, v16, 0
    v_dot2_f32_bf16 v32, v89, v17, v32
    v_dot2_f32_bf16 v33, v93, v17, v33
    v_dot2_f32_bf16 v34, v97, v17, v34
    v_dot2_f32_bf16 v35, v101, v17, v35
    v_dot2_f32_bf16 v32, v90, v18, v32
    v_dot2_f32_bf16 v33, v94, v18, v33
    v_dot2_f32_bf16 v34, v98, v18, v34
    v_dot2_f32_bf16 v35, v102, v18, v35
    v_dot2_f32_bf16 v32, v91, v19, v32
    v_dot2_f32_bf16 v33, v95, v19, v33
    v_dot2_f32_bf16 v34, v99, v19, v34
    v_dot2_f32_bf16 v35, v103, v19, v35
    s_nop 2
    v_add_f32_dpp v32, v32, v32 row_ror:8 row_mask:0xf bank_mask:0x3
    v_add_f32_dpp v34, v34, v34 row_ror:8 row_mask:0xf bank_mask:0x3
    v_add_f32_dpp v32, v33, v33 row_ror:8 row_mask:0xf bank_mask:0xc
    v_add_f32_dpp v34, v35, v35 row_ror:8 row_mask:0xf bank_mask:0xc
    s_nop 1
    v_add_f32_dpp v38, v32, v32 row_half_mirror row_mask:0xf bank_mask:0x5
    v_add_f32_dpp v38, v34, v34 row_half_mirror row_mask:0xf bank_mask:0xa
    s_waitcnt vmcnt(3)
    buffer_load_dwordx4 v[76:79], v4, s[32:35], s56 offen offset:1024 nt
    v_dot2_f32_bf16 v32, v104, v16, 0
    v_dot2_f32_bf16 v33, v108, v16, 0
    v_dot2_f32_bf16 v34, v112, v16, 0
    v_dot2_f32_bf16 v35, v116, v16, 0
    v_dot2_f32_bf16 v32, v105, v17, v32
    v_dot2_f32_bf16 v33, v109, v17, v33
    v_dot2_f32_bf16 v34, v113, v17, v34
    v_dot2_f32_bf16 v35, v117, v17, v35
    v_dot2_f32_bf16 v32, v106, v18, v32
    v_dot2_f32_bf16 v33, v110, v18, v33
    v_dot2_f32_bf16 v34, v114, v18, v34
    v_dot2_f32_bf16 v35, v118, v18, v35
    v_dot2_f32_bf16 v32, v107, v19, v32
    v_dot2_f32_bf16 v33, v111, v19, v33
    v_dot2_f32_bf16 v34, v115, v19, v34
    v_dot2_f32_bf16 v35, v119, v19, v35
    s_nop 2
    v_add_f32_dpp v32, v32, v32 row_ror:8 row_mask:0xf bank_mask:0x3
    v_add_f32_dpp v34, v34, v34 row_ror:8 row_mask:0xf bank_mask:0x3
    v_add_f32_dpp v32, v33, v33 row_ror:8 row_mask:0xf bank_mask:0xc
    v_add_f32_dpp v34, v35, v35 row_ror:8 row_mask:0xf bank_mask:0xc
    s_nop 1
    v_add_f32_dpp v39, v32, v32 row_half_mirror row_mask:0xf bank_mask:0x5
    v_add_f32_dpp v39, v34, v34 row_half_mirror row_mask:0xf bank_mask:0xa
    s_nop 1
    v_add_f32_dpp v36, v36, v36 quad_perm:[2,3,0,1] row_mask:0xf bank_mask:0xf
    v_add_f32_dpp v37, v37, v37 quad_perm:[2,3,0,1] row_mask:0xf bank_mask:0xf
    v_add_f32_dpp v38, v38, v38 quad_perm:[2,3,0,1] row_mask:0xf bank_mask:0xf
    v_add_f32_dpp v39, v39, v39 quad_perm:[2,3,0,1] row_mask:0xf bank_mask:0xf
    v_cndmask_b32 v36, v36, v37, s[64:65]
    v_cndmask_b32 v38, v38, v39, s[64:65]
    s_nop 1
    v_add_f32_dpp v36, v36, v36 quad_perm:[1,0,3,2] row_mask:0xf bank_mask:0xf
    v_add_f32_dpp v38, v38, v38 quad_perm:[1,0,3,2] row_mask:0xf bank_mask:0xf
    v_cndmask_b32 v28, v36, v38, s[66:67]
    s_barrier
    s_waitcnt vmcnt(3)
    buffer_load_dwordx4 v[180:183], v6, s[44:47], 0 offen offset:768 nt
    buffer_load_dwordx4 v[80:83], v4, s[32:35], s56 offen offset:2048 nt
    v_dot2_f32_bf16 v32, v120, v16, 0
    v_dot2_f32_bf16 v33, v124, v16, 0
    v_dot2_f32_bf16 v34, v128, v16, 0
    v_dot2_f32_bf16 v35, v132, v16, 0
    v_dot2_f32_bf16 v32, v121, v17, v32
    v_dot2_f32_bf16 v33, v125, v17, v33
    v_dot2_f32_bf16 v34, v129, v17, v34
    v_dot2_f32_bf16 v35, v133, v17, v35
    v_dot2_f32_bf16 v32, v122, v18, v32
    v_dot2_f32_bf16 v33, v126, v18, v33
    v_dot2_f32_bf16 v34, v130, v18, v34
    v_dot2_f32_bf16 v35, v134, v18, v35
    v_dot2_f32_bf16 v32, v123, v19, v32
    v_dot2_f32_bf16 v33, v127, v19, v33
    v_dot2_f32_bf16 v34, v131, v19, v34
    v_dot2_f32_bf16 v35, v135, v19, v35
    s_nop 2
    v_add_f32_dpp v32, v32, v32 row_ror:8 row_mask:0xf bank_mask:0x3
    v_add_f32_dpp v34, v34, v34 row_ror:8 row_mask:0xf bank_mask:0x3
    v_add_f32_dpp v32, v33, v33 row_ror:8 row_mask:0xf bank_mask:0xc
    v_add_f32_dpp v34, v35, v35 row_ror:8 row_mask:0xf bank_mask:0xc
    s_nop 1
    v_add_f32_dpp v36, v32, v32 row_half_mirror row_mask:0xf bank_mask:0x5
    v_add_f32_dpp v36, v34, v34 row_half_mirror row_mask:0xf bank_mask:0xa
    s_waitcnt vmcnt(3)
    buffer_load_dwordx4 v[84:87], v4, s[32:35], s56 offen offset:3072 nt
    v_dot2_f32_bf16 v32, v136, v16, 0
    v_dot2_f32_bf16 v33, v140, v16, 0
    v_dot2_f32_bf16 v34, v144, v16, 0
    v_dot2_f32_bf16 v35, v148, v16, 0
    v_dot2_f32_bf16 v32, v137, v17, v32
    v_dot2_f32_bf16 v33, v141, v17, v33
    v_dot2_f32_bf16 v34, v145, v17, v34
    v_dot2_f32_bf16 v35, v149, v17, v35
    v_dot2_f32_bf16 v32, v138, v18, v32
    v_dot2_f32_bf16 v33, v142, v18, v33
    v_dot2_f32_bf16 v34, v146, v18, v34
    v_dot2_f32_bf16 v35, v150, v18, v35
    v_dot2_f32_bf16 v32, v139, v19, v32
    v_dot2_f32_bf16 v33, v143, v19, v33
    v_dot2_f32_bf16 v34, v147, v19, v34
    v_dot2_f32_bf16 v35, v151, v19, v35
    s_nop 2
    v_add_f32_dpp v32, v32, v32 row_ror:8 row_mask:0xf bank_mask:0x3
    v_add_f32_dpp v34, v34, v34 row_ror:8 row_mask:0xf bank_mask:0x3
    v_add_f32_dpp v32, v33, v33 row_ror:8 row_mask:0xf bank_mask:0xc
    v_add_f32_dpp v34, v35, v35 row_ror:8 row_mask:0xf bank_mask:0xc
    s_nop 1
    v_add_f32_dpp v37, v32, v32 row_half_mirror row_mask:0xf bank_mask:0x5
    v_add_f32_dpp v37, v34, v34 row_half_mirror row_mask:0xf bank_mask:0xa
    s_barrier
    s_waitcnt vmcnt(3)
    buffer_load_dwordx4 v[184:187], v6, s[44:47], 0 offen offset:1024 nt
    s_mov_b32 s56, 196608
    buffer_load_dwordx4 v[88:91], v4, s[32:35], s56 offen nt
    v_dot2_f32_bf16 v32, v152, v16, 0
    v_dot2_f32_bf16 v33, v156, v16, 0
    v_dot2_f32_bf16 v34, v160, v16, 0
    v_dot2_f32_bf16 v35, v164, v16, 0
    v_dot2_f32_bf16 v32, v153, v17, v32
    v_dot2_f32_bf16 v33, v157, v17, v33
    v_dot2_f32_bf16 v34, v161, v17, v34
    v_dot2_f32_bf16 v35, v165, v17, v35
    v_dot2_f32_bf16 v32, v154, v18, v32
    v_dot2_f32_bf16 v33, v158, v18, v33
    v_dot2_f32_bf16 v34, v162, v18, v34
    v_dot2_f32_bf16 v35, v166, v18, v35
    v_dot2_f32_bf16 v32, v155, v19, v32
    v_dot2_f32_bf16 v33, v159, v19, v33
    v_dot2_f32_bf16 v34, v163, v19, v34
    v_dot2_f32_bf16 v35, v167, v19, v35
    s_nop 2
    v_add_f32_dpp v32, v32, v32 row_ror:8 row_mask:0xf bank_mask:0x3
    v_add_f32_dpp v34, v34, v34 row_ror:8 row_mask:0xf bank_mask:0x3
    v_add_f32_dpp v32, v33, v33 row_ror:8 row_mask:0xf bank_mask:0xc
    v_add_f32_dpp v34, v35, v35 row_ror:8 row_mask:0xf bank_mask:0xc
    s_nop 1
    v_add_f32_dpp v38, v32, v32 row_half_mirror row_mask:0xf bank_mask:0x5
    v_add_f32_dpp v38, v34, v34 row_half_mirror row_mask:0xf bank_mask:0xa
    s_waitcnt vmcnt(3)
    buffer_load_dwordx4 v[92:95], v4, s[32:35], s56 offen offset:1024 nt
    s_cmp_lg_u32 s30, 0
    s_cbranch_scc1 L_zl_4
    s_waitcnt lgkmcnt(0)
    s_load_dword s19, s[22:23], s63
    s_load_dword s70, s[22:23], 0
L_zl_4:
    v_dot2_f32_bf16 v32, v56, v16, 0
    v_dot2_f32_bf16 v33, v60, v16, 0
    v_dot2_f32_bf16 v34, v64, v16, 0
    v_dot2_f32_bf16 v35, v68, v16, 0
    v_dot2_f32_bf16 v32, v57, v17, v32
    v_dot2_f32_bf16 v33, v61, v17, v33
    v_dot2_f32_bf16 v34, v65, v17, v34
    v_dot2_f32_bf16 v35, v69, v17, v35
    v_dot2_f32_bf16 v32, v58, v18, v32
    v_dot2_f32_bf16 v33, v62, v18, v33
    v_dot2_f32_bf16 v34, v66, v18, v34
    v_dot2_f32_bf16 v35, v70, v18, v35
    v_dot2_f32_bf16 v32, v59, v19, v32
    v_dot2_f32_bf16 v33, v63, v19, v33
    v_dot2_f32_bf16 v34, v67, v19, v34
    v_dot2_f32_bf16 v35, v71, v19, v35
    s_nop 2
    v_add_f32_dpp v32, v32, v32 row_ror:8 row_mask:0xf bank_mask:0x3
    v_add_f32_dpp v34, v34, v34 row_ror:8 row_mask:0xf bank_mask:0x3
    v_add_f32_dpp v32, v33, v33 row_ror:8 row_mask:0xf bank_mask:0xc
    v_add_f32_dpp v34, v35, v35 row_ror:8 row_mask:0xf bank_mask:0xc
    s_nop 1
    v_add_f32_dpp v39, v32, v32 row_half_mirror row_mask:0xf bank_mask:0x5
    v_add_f32_dpp v39, v34, v34 row_half_mirror row_mask:0xf bank_mask:0xa
    s_nop 1
    v_add_f32_dpp v36, v36, v36 quad_perm:[2,3,0,1] row_mask:0xf bank_mask:0xf
    v_add_f32_dpp v37, v37, v37 quad_perm:[2,3,0,1] row_mask:0xf bank_mask:0xf
    v_add_f32_dpp v38, v38, v38 quad_perm:[2,3,0,1] row_mask:0xf bank_mask:0xf
    v_add_f32_dpp v39, v39, v39 quad_perm:[2,3,0,1] row_mask:0xf bank_mask:0xf
    v_cndmask_b32 v36, v36, v37, s[64:65]
    v_cndmask_b32 v38, v38, v39, s[64:65]
    s_nop 1
    v_add_f32_dpp v36, v36, v36 quad_perm:[1,0,3,2] row_mask:0xf bank_mask:0xf
    v_add_f32_dpp v38, v38, v38 quad_perm:[1,0,3,2] row_mask:0xf bank_mask:0xf
    v_cndmask_b32 v29, v36, v38, s[66:67]
    s_barrier
    s_mov_b32 s56, 5120
    buffer_load_dwordx4 v[188:191], v6, s[44:47], s56 offen nt
    s_mov_b32 s56, 196608
    buffer_load_dwordx4 v[96:99], v4, s[32:35], s56 offen offset:2048 nt
    s_waitcnt vmcnt(5)
    buffer_load_dwordx4 v[100:103], v4, s[32:35], s56 offen offset:3072 nt
    v_dot2_f32_bf16 v32, v72, v16, 0
    v_dot2_f32_bf16 v33, v76, v16, 0
    v_dot2_f32_bf16 v34, v80, v16, 0
    v_dot2_f32_bf16 v35, v84, v16, 0
    v_dot2_f32_bf16 v32, v73, v17, v32
    v_dot2_f32_bf16 v33, v77, v17, v33
    v_dot2_f32_bf16 v34, v81, v17, v34
    v_dot2_f32_bf16 v35, v85, v17, v35
    v_dot2_f32_bf16 v32, v74, v18, v32
    v_dot2_f32_bf16 v33, v78, v18, v33
    v_dot2_f32_bf16 v34, v82, v18, v34
    v_dot2_f32_bf16 v35, v86, v18, v35
    v_dot2_f32_bf16 v32, v75, v19, v32
    v_dot2_f32_bf16 v33, v79, v19, v33
    v_dot2_f32_bf16 v34, v83, v19, v34
    v_dot2_f32_bf16 v35, v87, v19, v35
    s_nop 2
    v_add_f32_dpp v32, v32, v32 row_ror:8 row_mask:0xf bank_mask:0x3
    v_add_f32_dpp v34, v34, v34 row_ror:8 row_mask:0xf bank_mask:0x3
    v_add_f32_dpp v32, v33, v33 row_ror:8 row_mask:0xf bank_mask:0xc
    v_add_f32_dpp v34, v35, v35 row_ror:8 row_mask:0xf bank_mask:0xc
    s_nop 1
    v_add_f32_dpp v36, v32, v32 row_half_mirror row_mask:0xf bank_mask:0x5
    v_add_f32_dpp v36, v34, v34 row_half_mirror row_mask:0xf bank_mask:0xa
    s_cmp_lg_u32 s30, 0
    s_cbranch_scc1 L_fr_5
    s_waitcnt lgkmcnt(0)
    s_mov_b32 s3, 8
    s_cmp_eq_u32 s70, 0
    s_cbranch_scc1 L_nf_6
    s_mov_b32 s3, 1
    s_atomic_add s3, s[24:25], s61 glc
L_nf_6:
    s_add_u32 s61, s61, 8192
L_fr_5:
    s_waitcnt vmcnt(4)
    s_mov_b32 s56, 5120
    buffer_load_dwordx4 v[192:195], v6, s[44:47], s56 offen offset:256 nt
    s_mov_b32 s56, 393216
    buffer_load_dwordx4 v[104:107], v4, s[32:35], s56 offen nt
    s_waitcnt vmcnt(5)
    buffer_load_dwordx4 v[108:111], v4, s[32:35], s56 offen offset:1024 nt
    s_waitcnt vmcnt(4)
    s_mov_b32 s56, 5120
    buffer_load_dwordx4 v[196:199], v6, s[44:47], s56 offen offset:512 nt
    s_mov_b32 s56, 393216
    buffer_load_dwordx4 v[112:115], v4, s[32:35], s56 offen offset:2048 nt
    s_waitcnt vmcnt(5)
    buffer_load_dwordx4 v[116:119], v4, s[32:35], s56 offen offset:3072 nt
    v_dot2_f32_bf16 v32, v88, v16, 0
    v_dot2_f32_bf16 v33, v92, v16, 0
    v_dot2_f32_bf16 v34, v96, v16, 0
    v_dot2_f32_bf16 v35, v100, v16, 0
    v_dot2_f32_bf16 v32, v89, v17, v32
    v_dot2_f32_bf16 v33, v93, v17, v33
    v_dot2_f32_bf16 v34, v97, v17, v34
    v_dot2_f32_bf16 v35, v101, v17, v35
    v_dot2_f32_bf16 v32, v90, v18, v32
    v_dot2_f32_bf16 v33, v94, v18, v33
    v_dot2_f32_bf16 v34, v98, v18, v34
    v_dot2_f32_bf16 v35, v102, v18, v35
    v_dot2_f32_bf16 v32, v91, v19, v32
    v_dot2_f32_bf16 v33, v95, v19, v33
    v_dot2_f32_bf16 v34, v99, v19, v34
    v_dot2_f32_bf16 v35, v103, v19, v35
    s_nop 2
    v_add_f32_dpp v32, v32, v32 row_ror:8 row_mask:0xf bank_mask:0x3
    v_add_f32_dpp v34, v34, v34 row_ror:8 row_mask:0xf bank_mask:0x3
    v_add_f32_dpp v32, v33, v33 row_ror:8 row_mask:0xf bank_mask:0xc
    v_add_f32_dpp v34, v35, v35 row_ror:8 row_mask:0xf bank_mask:0xc
    s_nop 1
    v_add_f32_dpp v37, v32, v32 row_half_mirror row_mask:0xf bank_mask:0x5
    v_add_f32_dpp v37, v34, v34 row_half_mirror row_mask:0xf bank_mask:0xa
    s_barrier
    s_cmp_lg_u32 s30, 0
    s_cbranch_scc1 L_fw_7
    s_waitcnt lgkmcnt(0)
    s_cmp_ge_u32 s3, 5
    s_cselect_b32 s57, 1, 0
    v_mov_b32 v55, s57
    ds_write_b32 v14, v55 offset:30976
L_fw_7:
    s_waitcnt vmcnt(4)
    s_mov_b32 s56, 5120
    buffer_load_dwordx4 v[200:203], v6, s[44:47], s56 offen offset:768 nt
    s_mov_b32 s56, 458752
    buffer_load_dwordx4 v[120:123], v4, s[32:35], s56 offen nt
    s_waitcnt vmcnt(5)
    buffer_load_dwordx4 v[124:127], v4, s[32:35], s56 offen offset:1024 nt
    s_waitcnt vmcnt(4)
    s_mov_b32 s56, 5120
    buffer_load_dwordx4 v[204:207], v6, s[44:47], s56 offen offset:1024 nt
    s_mov_b32 s56, 458752
    buffer_load_dwordx4 v[128:131], v4, s[32:35], s56 offen offset:2048 nt
    s_waitcnt vmcnt(5)
    buffer_load_dwordx4 v[132:135], v4, s[32:35], s56 offen offset:3072 nt
    ds_read_b32 v55, v14 offset:30976
    v_dot2_f32_bf16 v32, v104, v16, 0
    v_dot2_f32_bf16 v33, v108, v16, 0
    v_dot2_f32_bf16 v34, v112, v16, 0
    v_dot2_f32_bf16 v35, v116, v16, 0
    v_dot2_f32_bf16 v32, v105, v17, v32
    v_dot2_f32_bf16 v33, v109, v17, v33
    v_dot2_f32_bf16 v34, v113, v17, v34
    v_dot2_f32_bf16 v35, v117, v17, v35
    v_dot2_f32_bf16 v32, v106, v18, v32
    v_dot2_f32_bf16 v33, v110, v18, v33
    v_dot2_f32_bf16 v34, v114, v18, v34
    v_dot2_f32_bf16 v35, v118, v18, v35
    v_dot2_f32_bf16 v32, v107, v19, v32
    v_dot2_f32_bf16 v33, v111, v19, v33
    v_dot2_f32_bf16 v34, v115, v19, v34
    v_dot2_f32_bf16 v35, v119, v19, v35
    s_nop 2
    v_add_f32_dpp v32, v32, v32 row_ror:8 row_mask:0xf bank_mask:0x3
    v_add_f32_dpp v34, v34, v34 row_ror:8 row_mask:0xf bank_mask:0x3
    v_add_f32_dpp v32, v33, v33 row_ror:8 row_mask:0xf bank_mask:0xc
    v_add_f32_dpp v34, v35, v35 row_ror:8 row_mask:0xf bank_mask:0xc
    s_nop 1
    v_add_f32_dpp v38, v32, v32 row_half_mirror row_mask:0xf bank_mask:0x5
    v_add_f32_dpp v38, v34, v34 row_half_mirror row_mask:0xf bank_mask:0xa
    s_waitcnt lgkmcnt(0)
    v_readfirstlane_b32 s57, v55
    s_nop 3
    s_cmp_lg_u32 s57, 0
    s_cselect_b64 vcc, -1, 0
    s_waitcnt vmcnt(4)
    s_cbranch_vccnz L_sh_8
    s_waitcnt vmcnt(2)
L_sh_8:
    s_mov_b32 s56, 10240
    buffer_load_dwordx4 v[208:211], v6, s[44:47], s56 offen nt
    s_mov_b32 s56, 655360
    buffer_load_dwordx4 v[136:139], v15, s[32:35], s56 offen nt
    s_waitcnt vmcnt(5)
    s_cbranch_vccnz L_sh_9
    s_waitcnt vmcnt(2)
L_sh_9:
    buffer_load_dwordx4 v[140:143], v15, s[32:35], s56 offen offset:1024 nt
    s_waitcnt vmcnt(4)
    s_cbranch_vccnz L_sh_10
    s_waitcnt vmcnt(2)
L_sh_10:
    s_mov_b32 s56, 10240
    buffer_load_dwordx4 v[212:215], v6, s[44:47], s56 offen offset:256 nt
    s_mov_b32 s56, 655360
    buffer_load_dwordx4 v[144:147], v15, s[32:35], s56 offen offset:2048 nt
    s_waitcnt vmcnt(5)
    s_cbranch_vccnz L_sh_11
    s_waitcnt vmcnt(2)
L_sh_11:
    buffer_load_dwordx4 v[148:151], v15, s[32:35], s56 offen offset:3072 nt
    ds_read_b32 v55, v14 offset:30976
    v_dot2_f32_bf16 v32, v120, v16, 0
    v_dot2_f32_bf16 v33, v124, v16, 0
    v_dot2_f32_bf16 v34, v128, v16, 0
    v_dot2_f32_bf16 v35, v132, v16, 0
    v_dot2_f32_bf16 v32, v121, v17, v32
    v_dot2_f32_bf16 v33, v125, v17, v33
    v_dot2_f32_bf16 v34, v129, v17, v34
    v_dot2_f32_bf16 v35, v133, v17, v35
    v_dot2_f32_bf16 v32, v122, v18, v32
    v_dot2_f32_bf16 v33, v126, v18, v33
    v_dot2_f32_bf16 v34, v130, v18, v34
    v_dot2_f32_bf16 v35, v134, v18, v35
    v_dot2_f32_bf16 v32, v123, v19, v32
    v_dot2_f32_bf16 v33, v127, v19, v33
    v_dot2_f32_bf16 v34, v131, v19, v34
    v_dot2_f32_bf16 v35, v135, v19, v35
    s_nop 2
    v_add_f32_dpp v32, v32, v32 row_ror:8 row_mask:0xf bank_mask:0x3
    v_add_f32_dpp v34, v34, v34 row_ror:8 row_mask:0xf bank_mask:0x3
    v_add_f32_dpp v32, v33, v33 row_ror:8 row_mask:0xf bank_mask:0xc
    v_add_f32_dpp v34, v35, v35 row_ror:8 row_mask:0xf bank_mask:0xc
    s_nop 1
    v_add_f32_dpp v39, v32, v32 row_half_mirror row_mask:0xf bank_mask:0x5
    v_add_f32_dpp v39, v34, v34 row_half_mirror row_mask:0xf bank_mask:0xa
    s_nop 1
    v_add_f32_dpp v36, v36, v36 quad_perm:[2,3,0,1] row_mask:0xf bank_mask:0xf
    v_add_f32_dpp v37, v37, v37 quad_perm:[2,3,0,1] row_mask:0xf bank_mask:0xf
    v_add_f32_dpp v38, v38, v38 quad_perm:[2,3,0,1] row_mask:0xf bank_mask:0xf
    v_add_f32_dpp v39, v39, v39 quad_perm:[2,3,0,1] row_mask:0xf bank_mask:0xf
    v_cndmask_b32 v36, v36, v37, s[64:65]
    v_cndmask_b32 v38, v38, v39, s[64:65]
    s_nop 1
    v_add_f32_dpp v36, v36, v36 quad_perm:[1,0,3,2] row_mask:0xf bank_mask:0xf
    v_add_f32_dpp v38, v38, v38 quad_perm:[1,0,3,2] row_mask:0xf bank_mask:0xf
    v_cndmask_b32 v30, v36, v38, s[66:67]
    s_barrier
    s_waitcnt lgkmcnt(0)
    v_readfirstlane_b32 s57, v55
    s_nop 3
    s_cmp_lg_u32 s57, 0
    s_cselect_b64 vcc, -1, 0
    s_cmp_lg_u32 s30, 0
    s_cbranch_scc1 L_fr_12
    s_waitcnt lgkmcnt(0)
    s_mov_b32 s3, 8
    s_cmp_eq_u32 s70, 0
    s_cbranch_scc1 L_nf_13
    s_mov_b32 s3, 1
    s_atomic_add s3, s[24:25], s61 glc
L_nf_13:
    s_add_u32 s61, s61, 8192
L_fr_12:
    s_waitcnt vmcnt(4)
    s_cbranch_vccnz L_sh_14
    s_waitcnt vmcnt(2)
L_sh_14:
    s_mov_b32 s56, 10240
    buffer_load_dwordx4 v[216:219], v6, s[44:47], s56 offen offset:512 nt
    s_mov_b32 s56, 720896
    buffer_load_dwordx4 v[152:155], v15, s[32:35], s56 offen nt
    s_waitcnt vmcnt(5)
    s_cbranch_vccnz L_sh_15
    s_waitcnt vmcnt(2)
L_sh_15:
    buffer_load_dwordx4 v[156:159], v15, s[32:35], s56 offen offset:1024 nt
    s_waitcnt vmcnt(4)
    s_cbranch_vccnz L_sh_16
    s_waitcnt vmcnt(2)
L_sh_16:
    s_mov_b32 s56, 10240
    buffer_load_dwordx4 v[220:223], v6, s[44:47], s56 offen offset:768 nt
    s_mov_b32 s56, 720896
    buffer_load_dwordx4 v[160:163], v15, s[32:35], s56 offen offset:2048 nt
    s_waitcnt vmcnt(5)
    s_cbranch_vccnz L_sh_17
    s_waitcnt vmcnt(2)
L_sh_17:
    buffer_load_dwordx4 v[164:167], v15, s[32:35], s56 offen offset:3072 nt
    ds_read_b32 v55, v14 offset:30976
    v_dot2_f32_bf16 v32, v136, v16, 0
    v_dot2_f32_bf16 v33, v140, v16, 0
    v_dot2_f32_bf16 v34, v144, v16, 0
    v_dot2_f32_bf16 v35, v148, v16, 0
    v_dot2_f32_bf16 v32, v137, v17, v32
    v_dot2_f32_bf16 v33, v141, v17, v33
    v_dot2_f32_bf16 v34, v145, v17, v34
    v_dot2_f32_bf16 v35, v149, v17, v35
    v_dot2_f32_bf16 v32, v138, v18, v32
    v_dot2_f32_bf16 v33, v142, v18, v33
    v_dot2_f32_bf16 v34, v146, v18, v34
    v_dot2_f32_bf16 v35, v150, v18, v35
    v_dot2_f32_bf16 v32, v139, v19, v32
    v_dot2_f32_bf16 v33, v143, v19, v33
    v_dot2_f32_bf16 v34, v147, v19, v34
    v_dot2_f32_bf16 v35, v151, v19, v35
    s_nop 2
    v_add_f32_dpp v32, v32, v32 row_ror:8 row_mask:0xf bank_mask:0x3
    v_add_f32_dpp v34, v34, v34 row_ror:8 row_mask:0xf bank_mask:0x3
    v_add_f32_dpp v32, v33, v33 row_ror:8 row_mask:0xf bank_mask:0xc
    v_add_f32_dpp v34, v35, v35 row_ror:8 row_mask:0xf bank_mask:0xc
    s_nop 1
    v_add_f32_dpp v36, v32, v32 row_half_mirror row_mask:0xf bank_mask:0x5
    v_add_f32_dpp v36, v34, v34 row_half_mirror row_mask:0xf bank_mask:0xa
    s_waitcnt lgkmcnt(0)
    v_readfirstlane_b32 s57, v55
    s_nop 3
    s_cmp_lg_u32 s57, 0
    s_cselect_b64 vcc, -1, 0
    s_cmp_lg_u32 s30, 0
    s_cbranch_scc1 L_fw_18
    s_waitcnt lgkmcnt(0)
    s_cmp_ge_u32 s3, 5
    s_cselect_b32 s57, 1, 0
    v_mov_b32 v55, s57
    ds_write_b32 v14, v55 offset:30976
L_fw_18:
    s_waitcnt vmcnt(4)
    s_cbranch_vccnz L_sh_19
    s_waitcnt vmcnt(2)
L_sh_19:
    s_mov_b32 s56, 10240
    buffer_load_dwordx4 v[224:227], v6, s[44:47], s56 offen offset:1024 nt
    s_mov_b32 s56, 917504
    buffer_load_dwordx4 v[56:59], v15, s[32:35], s56 offen nt
    s_waitcnt vmcnt(5)
    s_cbranch_vccnz L_sh_20
    s_waitcnt vmcnt(2)
L_sh_20:
    buffer_load_dwordx4 v[60:63], v15, s[32:35], s56 offen offset:1024 nt
    s_waitcnt vmcnt(4)
    s_cbranch_vccnz L_sh_21
    s_waitcnt vmcnt(2)
L_sh_21:
    s_mov_b32 s56, 15360
    buffer_load_dwordx4 v[228:231], v6, s[44:47], s56 offen nt
    s_mov_b32 s56, 917504
    buffer_load_dwordx4 v[64:67], v15, s[32:35], s56 offen offset:2048 nt
    s_waitcnt vmcnt(5)
    s_cbranch_vccnz L_sh_22
    s_waitcnt vmcnt(2)
L_sh_22:
    buffer_load_dwordx4 v[68:71], v15, s[32:35], s56 offen offset:3072 nt
    ds_read_b32 v55, v14 offset:30976
    v_dot2_f32_bf16 v32, v152, v16, 0
    v_dot2_f32_bf16 v33, v156, v16, 0
    v_dot2_f32_bf16 v34, v160, v16, 0
    v_dot2_f32_bf16 v35, v164, v16, 0
    v_dot2_f32_bf16 v32, v153, v17, v32
    v_dot2_f32_bf16 v33, v157, v17, v33
    v_dot2_f32_bf16 v34, v161, v17, v34
    v_dot2_f32_bf16 v35, v165, v17, v35
    v_dot2_f32_bf16 v32, v154, v18, v32
    v_dot2_f32_bf16 v33, v158, v18, v33
    v_dot2_f32_bf16 v34, v162, v18, v34
    v_dot2_f32_bf16 v35, v166, v18, v35
    v_dot2_f32_bf16 v32, v155, v19, v32
    v_dot2_f32_bf16 v33, v159, v19, v33
    v_dot2_f32_bf16 v34, v163, v19, v34
    v_dot2_f32_bf16 v35, v167, v19, v35
    s_nop 2
    v_add_f32_dpp v32, v32, v32 row_ror:8 row_mask:0xf bank_mask:0x3
    v_add_f32_dpp v34, v34, v34 row_ror:8 row_mask:0xf bank_mask:0x3
    v_add_f32_dpp v32, v33, v33 row_ror:8 row_mask:0xf bank_mask:0xc
    v_add_f32_dpp v34, v35, v35 row_ror:8 row_mask:0xf bank_mask:0xc
    s_nop 1
    v_add_f32_dpp v37, v32, v32 row_half_mirror row_mask:0xf bank_mask:0x5
    v_add_f32_dpp v37, v34, v34 row_half_mirror row_mask:0xf bank_mask:0xa
    s_barrier
    s_waitcnt lgkmcnt(0)
    v_readfirstlane_b32 s57, v55
    s_nop 3
    s_cmp_lg_u32 s57, 0
    s_cselect_b64 vcc, -1, 0
    s_waitcnt vmcnt(4)
    s_cbranch_vccnz L_sh_23
    s_waitcnt vmcnt(2)
L_sh_23:
    s_mov_b32 s56, 15360
    buffer_load_dwordx4 v[232:235], v6, s[44:47], s56 offen offset:256 nt
    s_mov_b32 s56, 983040
    buffer_load_dwordx4 v[72:75], v15, s[32:35], s56 offen nt
    s_waitcnt vmcnt(5)
    s_cbranch_vccnz L_sh_24
    s_waitcnt vmcnt(2)
L_sh_24:
    buffer_load_dwordx4 v[76:79], v15, s[32:35], s56 offen offset:1024 nt
    s_waitcnt vmcnt(4)
    s_cbranch_vccnz L_sh_25
    s_waitcnt vmcnt(2)
L_sh_25:
    s_mov_b32 s56, 15360
    buffer_load_dwordx4 v[236:239], v6, s[44:47], s56 offen offset:512 nt
    s_mov_b32 s56, 983040
    buffer_load_dwordx4 v[80:83], v15, s[32:35], s56 offen offset:2048 nt
    s_waitcnt vmcnt(5)
    s_cbranch_vccnz L_sh_26
    s_waitcnt vmcnt(2)
L_sh_26:
    buffer_load_dwordx4 v[84:87], v15, s[32:35], s56 offen offset:3072 nt
    ds_read_b32 v55, v14 offset:30976
    v_dot2_f32_bf16 v32, v56, v16, 0
    v_dot2_f32_bf16 v33, v60, v16, 0
    v_dot2_f32_bf16 v34, v64, v16, 0
    v_dot2_f32_bf16 v35, v68, v16, 0
    v_dot2_f32_bf16 v32, v57, v17, v32
    v_dot2_f32_bf16 v33, v61, v17, v33
    v_dot2_f32_bf16 v34, v65, v17, v34
    v_dot2_f32_bf16 v35, v69, v17, v35
    v_dot2_f32_bf16 v32, v58, v18, v32
    v_dot2_f32_bf16 v33, v62, v18, v33
    v_dot2_f32_bf16 v34, v66, v18, v34
    v_dot2_f32_bf16 v35, v70, v18, v35
    v_dot2_f32_bf16 v32, v59, v19, v32
    v_dot2_f32_bf16 v33, v63, v19, v33
    v_dot2_f32_bf16 v34, v67, v19, v34
    v_dot2_f32_bf16 v35, v71, v19, v35
    s_nop 2
    v_add_f32_dpp v32, v32, v32 row_ror:8 row_mask:0xf bank_mask:0x3
    v_add_f32_dpp v34, v34, v34 row_ror:8 row_mask:0xf bank_mask:0x3
    v_add_f32_dpp v32, v33, v33 row_ror:8 row_mask:0xf bank_mask:0xc
    v_add_f32_dpp v34, v35, v35 row_ror:8 row_mask:0xf bank_mask:0xc
    s_nop 1
    v_add_f32_dpp v38, v32, v32 row_half_mirror row_mask:0xf bank_mask:0x5
    v_add_f32_dpp v38, v34, v34 row_half_mirror row_mask:0xf bank_mask:0xa
    s_waitcnt lgkmcnt(0)
    v_readfirstlane_b32 s57, v55
    s_nop 3
    s_cmp_lg_u32 s57, 0
    s_cselect_b64 vcc, -1, 0
    s_cmp_lg_u32 s30, 0
    s_cbranch_scc1 L_fr_27
    s_waitcnt lgkmcnt(0)
    s_mov_b32 s3, 8
    s_cmp_eq_u32 s70, 0
    s_cbranch_scc1 L_nf_28
    s_mov_b32 s3, 1
    s_atomic_add s3, s[24:25], s61 glc
L_nf_28:
    s_add_u32 s61, s61, 8192
L_fr_27:
    s_waitcnt vmcnt(4)
    s_cbranch_vccnz L_sh_29
    s_waitcnt vmcnt(2)
L_sh_29:
    s_mov_b32 s56, 15360
    buffer_load_dwordx4 v[240:243], v6, s[44:47], s56 offen offset:768 nt
    buffer_load_dwordx4 v[88:91], v4, s[36:39], 0 offen nt
    s_waitcnt vmcnt(5)
    s_cbranch_vccnz L_sh_30
    s_waitcnt vmcnt(2)
L_sh_30:
    buffer_load_dwordx4 v[92:95], v4, s[36:39], 0 offen offset:1024 nt
    s_waitcnt vmcnt(4)
    s_cbranch_vccnz L_sh_31
    s_waitcnt vmcnt(2)
L_sh_31:
    buffer_load_dwordx4 v[244:247], v6, s[44:47], s56 offen offset:1024 nt
    buffer_load_dwordx4 v[96:99], v4, s[36:39], 0 offen offset:2048 nt
    s_waitcnt vmcnt(5)
    s_cbranch_vccnz L_sh_32
    s_waitcnt vmcnt(2)
L_sh_32:
    buffer_load_dwordx4 v[100:103], v4, s[36:39], 0 offen offset:3072 nt
    ds_read_b32 v55, v14 offset:30976
    v_dot2_f32_bf16 v32, v72, v16, 0
    v_dot2_f32_bf16 v33, v76, v16, 0
    v_dot2_f32_bf16 v34, v80, v16, 0
    v_dot2_f32_bf16 v35, v84, v16, 0
    v_dot2_f32_bf16 v32, v73, v17, v32
    v_dot2_f32_bf16 v33, v77, v17, v33
    v_dot2_f32_bf16 v34, v81, v17, v34
    v_dot2_f32_bf16 v35, v85, v17, v35
    v_dot2_f32_bf16 v32, v74, v18, v32
    v_dot2_f32_bf16 v33, v78, v18, v33
    v_dot2_f32_bf16 v34, v82, v18, v34
    v_dot2_f32_bf16 v35, v86, v18, v35
    v_dot2_f32_bf16 v32, v75, v19, v32
    v_dot2_f32_bf16 v33, v79, v19, v33
    v_dot2_f32_bf16 v34, v83, v19, v34
    v_dot2_f32_bf16 v35, v87, v19, v35
    s_nop 2
    v_add_f32_dpp v32, v32, v32 row_ror:8 row_mask:0xf bank_mask:0x3
    v_add_f32_dpp v34, v34, v34 row_ror:8 row_mask:0xf bank_mask:0x3
    v_add_f32_dpp v32, v33, v33 row_ror:8 row_mask:0xf bank_mask:0xc
    v_add_f32_dpp v34, v35, v35 row_ror:8 row_mask:0xf bank_mask:0xc
    s_nop 1
    v_add_f32_dpp v39, v32, v32 row_half_mirror row_mask:0xf bank_mask:0x5
    v_add_f32_dpp v39, v34, v34 row_half_mirror row_mask:0xf bank_mask:0xa
    s_nop 1
    v_add_f32_dpp v36, v36, v36 quad_perm:[2,3,0,1] row_mask:0xf bank_mask:0xf
    v_add_f32_dpp v37, v37, v37 quad_perm:[2,3,0,1] row_mask:0xf bank_mask:0xf
    v_add_f32_dpp v38, v38, v38 quad_perm:[2,3,0,1] row_mask:0xf bank_mask:0xf
    v_add_f32_dpp v39, v39, v39 quad_perm:[2,3,0,1] row_mask:0xf bank_mask:0xf
    v_cndmask_b32 v36, v36, v37, s[64:65]
    v_cndmask_b32 v38, v38, v39, s[64:65]
    s_nop 1
    v_add_f32_dpp v36, v36, v36 quad_perm:[1,0,3,2] row_mask:0xf bank_mask:0xf
    v_add_f32_dpp v38, v38, v38 quad_perm:[1,0,3,2] row_mask:0xf bank_mask:0xf
    v_cndmask_b32 v31, v36, v38, s[66:67]
    v_max_f32 v48, v28, v29
    v_max3_f32 v48, v48, v30, v31
    s_nop 1
    v_max_f32_dpp v48, v48, v48 row_ror:8 row_mask:0xf bank_mask:0xf
    s_nop 1
    v_max_f32_dpp v48, v48, v48 row_ror:4 row_mask:0xf bank_mask:0xf
    s_nop 1
    v_max_f32_dpp v48, v48, v48 row_ror:2 row_mask:0xf bank_mask:0xf
    s_nop 1
    v_max_f32_dpp v48, v48, v48 row_ror:1 row_mask:0xf bank_mask:0xf
    s_lshl_b32 s57, s30, 4
    v_lshl_add_u32 v12, v3, 2, s57
    s_mov_b32 exec_lo, 0x00010001
    s_mov_b32 exec_hi, 0x00010001
    ds_write_b32 v12, v48 offset:6144
    s_mov_b64 exec, -1
    v_lshlrev_b32 v13, 3, v2
    s_waitcnt lgkmcnt(0)
    s_barrier
    ds_read_b64 v[50:51], v13 offset:6144
    s_waitcnt lgkmcnt(0)
    v_max_f32 v48, v50, v51
    s_nop 1
    v_max_f32_dpp v48, v48, v48 row_ror:8 row_mask:0xf bank_mask:0xf
    s_nop 1
    v_max_f32_dpp v48, v48, v48 row_ror:4 row_mask:0xf bank_mask:0xf
    s_nop 1
    v_max_f32_dpp v48, v48, v48 row_ror:2 row_mask:0xf bank_mask:0xf
    s_nop 1
    v_max_f32_dpp v48, v48, v48 row_ror:1 row_mask:0xf bank_mask:0xf
    v_mul_f32 v5, s68, v48
    v_fma_f32 v28, v28, s68, -v5
    v_fma_f32 v29, v29, s68, -v5
    v_fma_f32 v30, v30, s68, -v5
    v_fma_f32 v31, v31, s68, -v5
    v_exp_f32 v28, v28
    v_exp_f32 v29, v29
    v_exp_f32 v30, v30
    v_exp_f32 v31, v31
    s_nop 0
    v_cvt_pk_bf16_f32 v28, v28, v28
    v_cvt_pk_bf16_f32 v29, v29, v29
    v_cvt_pk_bf16_f32 v30, v30, v30
    v_cvt_pk_bf16_f32 v31, v31, v31
    v_and_b32 v32, 0xffff0000, v28
    v_and_b32 v33, 0xffff0000, v29
    v_and_b32 v34, 0xffff0000, v30
    v_and_b32 v35, 0xffff0000, v31
    v_add_f32 v50, v32, v33
    v_add_f32 v34, v34, v35
    v_add_f32 v50, v50, v34
    s_nop 1
    v_add_f32_dpp v50, v50, v50 row_ror:8 row_mask:0xf bank_mask:0xf
    s_nop 1
    v_add_f32_dpp v50, v50, v50 row_ror:4 row_mask:0xf bank_mask:0xf
    s_nop 1
    v_add_f32_dpp v50, v50, v50 row_ror:2 row_mask:0xf bank_mask:0xf
    s_nop 1
    v_add_f32_dpp v50, v50, v50 row_ror:1 row_mask:0xf bank_mask:0xf
    s_mov_b32 exec_lo, 0x00010001
    s_mov_b32 exec_hi, 0x00010001
    ds_write_b32 v12, v50 offset:6272
    s_mov_b64 exec, -1
    s_waitcnt lgkmcnt(0)
    s_barrier
    s_mov_b32 s64, 0x07fe07fe
    s_mov_b32 s65, 0x07fe07fe
    s_lshl_b32 s57, s30, 3
    v_add_u32 v16, s57, v3
    v_mul_u32_u24 v16, 10, v16
    v_add3_u32 v16, v16, v2, -1
    v_max_i32 v16, 0, v16
    v_lshlrev_b32 v16, 2, v16
    v_add_u32 v17, 160, v16
    v_min_u32 v18, 1, v2
    v_cvt_f32_u32 v18, v18
    v_sub_f32 v18, 1.0, v18
    s_lshl_b32 s57, s30, 9
    v_lshl_add_u32 v19, v1, 2, s57
    s_waitcnt lgkmcnt(0)
    v_readfirstlane_b32 s57, v55
    s_nop 3
    s_cmp_lg_u32 s57, 0
    s_cselect_b64 vcc, -1, 0
    s_cmp_lg_u32 s30, 0
    s_cbranch_scc1 L_fw_33
    s_waitcnt lgkmcnt(0)
    s_cmp_ge_u32 s3, 5
    s_cselect_b32 s57, 1, 0
    v_mov_b32 v55, s57
    ds_write_b32 v14, v55 offset:30976
L_fw_33:
    s_cmp_lg_u32 s30, 0
    s_cbranch_scc1 L_pub_34
    ds_read_b64 v[50:51], v13 offset:6272
    s_waitcnt lgkmcnt(0)
    v_add_f32 v50, v50, v51
    s_nop 1
    v_add_f32_dpp v50, v50, v50 row_ror:8 row_mask:0xf bank_mask:0xf
    s_nop 1
    v_add_f32_dpp v50, v50, v50 row_ror:4 row_mask:0xf bank_mask:0xf
    s_nop 1
    v_add_f32_dpp v50, v50, v50 row_ror:2 row_mask:0xf bank_mask:0xf
    s_nop 1
    v_add_f32_dpp v50, v50, v50 row_ror:1 row_mask:0xf bank_mask:0xf
    v_log_f32 v50, v50
    s_nop 0
    v_add_f32 v50, v50, v5
    s_nop 0
    v_readfirstlane_b32 s6, v50
    s_cmp_lg_u32 s19, 0
    s_cbranch_scc1 L_zok_35
    s_mov_b32 s60, 0
L_zsp_36:
    s_atomic_or s19, s[22:23], s63 glc
    s_add_u32 s60, s60, 1
    s_lshr_b32 s58, s60, 18
    s_waitcnt lgkmcnt(0)
    s_or_b32 s58, s58, s19
    s_cmp_eq_u32 s58, 0
    s_cbranch_scc1 L_zsp_36
L_zok_35:
    s_not_b32 s7, s6
    s_max_u32 s7, s7, 1
    s_atomic_swap s7, s[24:25], s62 glc
L_pub_34:
    v_and_b32_dpp v32, v28, v20 row_newbcast:0 row_mask:0xf bank_mask:0xf
    v_and_b32_dpp v33, v28, v21 row_newbcast:0 row_mask:0xf bank_mask:0xf
    v_and_b32_dpp v34, v28, v22 row_newbcast:0 row_mask:0xf bank_mask:0xf
    v_and_b32_dpp v35, v28, v23 row_newbcast:0 row_mask:0xf bank_mask:0xf
    v_and_b32_dpp v36, v28, v20 row_newbcast:8 row_mask:0xf bank_mask:0xf
    v_and_b32_dpp v37, v28, v21 row_newbcast:8 row_mask:0xf bank_mask:0xf
    v_and_b32_dpp v38, v28, v22 row_newbcast:8 row_mask:0xf bank_mask:0xf
    v_and_b32_dpp v39, v28, v23 row_newbcast:8 row_mask:0xf bank_mask:0xf
    v_and_b32_dpp v40, v28, v20 row_newbcast:4 row_mask:0xf bank_mask:0xf
    v_and_b32_dpp v41, v28, v21 row_newbcast:4 row_mask:0xf bank_mask:0xf
    v_and_b32_dpp v42, v28, v22 row_newbcast:4 row_mask:0xf bank_mask:0xf
    v_and_b32_dpp v43, v28, v23 row_newbcast:4 row_mask:0xf bank_mask:0xf
    v_and_b32_dpp v44, v28, v20 row_newbcast:12 row_mask:0xf bank_mask:0xf
    v_and_b32_dpp v45, v28, v21 row_newbcast:12 row_mask:0xf bank_mask:0xf
    v_and_b32_dpp v46, v28, v22 row_newbcast:12 row_mask:0xf bank_mask:0xf
    v_and_b32_dpp v47, v28, v23 row_newbcast:12 row_mask:0xf bank_mask:0xf
    s_waitcnt vmcnt(4)
    s_cbranch_vccnz L_sh_37
    s_waitcnt vmcnt(2)
L_sh_37:
    s_mov_b32 s56, 65536
    buffer_load_dwordx4 v[104:107], v4, s[36:39], s56 offen nt
    s_waitcnt vmcnt(4)
    s_cbranch_vccnz L_sh_38
    s_waitcnt vmcnt(2)
L_sh_38:
    buffer_load_dwordx4 v[108:111], v4, s[36:39], s56 offen offset:1024 nt
    s_waitcnt vmcnt(3)
    s_cbranch_vccnz L_sh_39
    s_waitcnt vmcnt(2)
L_sh_39:
    buffer_load_dwordx4 v[112:115], v4, s[36:39], s56 offen offset:2048 nt
    s_waitcnt vmcnt(3)
    s_cbranch_vccnz L_sh_40
    s_waitcnt vmcnt(2)
L_sh_40:
    buffer_load_dwordx4 v[116:119], v4, s[36:39], s56 offen offset:3072 nt
    ds_read_b32 v55, v14 offset:30976
    s_nop 1
    v_mfma_f32_16x16x32_bf16 v[24:27], v[32:35], v[88:91], 0
    v_mfma_f32_16x16x32_bf16 v[24:27], v[36:39], v[92:95], v[24:27]
    v_mfma_f32_16x16x32_bf16 v[24:27], v[40:43], v[96:99], v[24:27]
    v_mfma_f32_16x16x32_bf16 v[24:27], v[44:47], v[100:103], v[24:27]
    s_waitcnt lgkmcnt(0)
    v_readfirstlane_b32 s57, v55
    s_nop 3
    s_cmp_lg_u32 s57, 0
    s_cselect_b64 vcc, -1, 0
    v_and_b32_dpp v32, v28, v20 row_newbcast:2 row_mask:0xf bank_mask:0xf
    v_and_b32_dpp v33, v28, v21 row_newbcast:2 row_mask:0xf bank_mask:0xf
    v_and_b32_dpp v34, v28, v22 row_newbcast:2 row_mask:0xf bank_mask:0xf
    v_and_b32_dpp v35, v28, v23 row_newbcast:2 row_mask:0xf bank_mask:0xf
    v_and_b32_dpp v36, v28, v20 row_newbcast:10 row_mask:0xf bank_mask:0xf
    v_and_b32_dpp v37, v28, v21 row_newbcast:10 row_mask:0xf bank_mask:0xf
    v_and_b32_dpp v38, v28, v22 row_newbcast:10 row_mask:0xf bank_mask:0xf
    v_and_b32_dpp v39, v28, v23 row_newbcast:10 row_mask:0xf bank_mask:0xf
    v_and_b32_dpp v40, v28, v20 row_newbcast:6 row_mask:0xf bank_mask:0xf
    v_and_b32_dpp v41, v28, v21 row_newbcast:6 row_mask:0xf bank_mask:0xf
    v_and_b32_dpp v42, v28, v22 row_newbcast:6 row_mask:0xf bank_mask:0xf
    v_and_b32_dpp v43, v28, v23 row_newbcast:6 row_mask:0xf bank_mask:0xf
    v_and_b32_dpp v44, v28, v20 row_newbcast:14 row_mask:0xf bank_mask:0xf
    v_and_b32_dpp v45, v28, v21 row_newbcast:14 row_mask:0xf bank_mask:0xf
    v_and_b32_dpp v46, v28, v22 row_newbcast:14 row_mask:0xf bank_mask:0xf
    v_and_b32_dpp v47, v28, v23 row_newbcast:14 row_mask:0xf bank_mask:0xf
    s_waitcnt vmcnt(3)
    s_cbranch_vccnz L_sh_41
    s_waitcnt vmcnt(2)
L_sh_41:
    s_mov_b32 s56, 262144
    buffer_load_dwordx4 v[120:123], v4, s[36:39], s56 offen nt
    s_waitcnt vmcnt(3)
    s_cbranch_vccnz L_sh_42
    s_waitcnt vmcnt(2)
L_sh_42:
    buffer_load_dwordx4 v[124:127], v4, s[36:39], s56 offen offset:1024 nt
    s_waitcnt vmcnt(3)
    s_cbranch_vccnz L_sh_43
    s_waitcnt vmcnt(2)
L_sh_43:
    buffer_load_dwordx4 v[128:131], v4, s[36:39], s56 offen offset:2048 nt
    s_waitcnt vmcnt(3)
    s_cbranch_vccnz L_sh_44
    s_waitcnt vmcnt(2)
L_sh_44:
    buffer_load_dwordx4 v[132:135], v4, s[36:39], s56 offen offset:3072 nt
    ds_read_b32 v55, v14 offset:30976
    s_nop 1
    v_mfma_f32_16x16x32_bf16 v[24:27], v[32:35], v[104:107], v[24:27]
    v_mfma_f32_16x16x32_bf16 v[24:27], v[36:39], v[108:111], v[24:27]
    v_mfma_f32_16x16x32_bf16 v[24:27], v[40:43], v[112:115], v[24:27]
    v_mfma_f32_16x16x32_bf16 v[24:27], v[44:47], v[116:119], v[24:27]
    s_barrier
    s_waitcnt lgkmcnt(0)
    v_readfirstlane_b32 s57, v55
    s_nop 3
    s_cmp_lg_u32 s57, 0
    s_cselect_b64 vcc, -1, 0
    s_cmp_lg_u32 s30, 0
    s_cbranch_scc1 L_fr_45
    s_waitcnt lgkmcnt(0)
    s_mov_b32 s3, 8
    s_cmp_eq_u32 s70, 0
    s_cbranch_scc1 L_nf_46
    s_mov_b32 s3, 1
    s_atomic_add s3, s[24:25], s61 glc
L_nf_46:
    s_add_u32 s61, s61, 8192
L_fr_45:
    v_and_b32_dpp v32, v28, v20 row_newbcast:1 row_mask:0xf bank_mask:0xf
    v_and_b32_dpp v33, v28, v21 row_newbcast:1 row_mask:0xf bank_mask:0xf
    v_and_b32_dpp v34, v28, v22 row_newbcast:1 row_mask:0xf bank_mask:0xf
    v_and_b32_dpp v35, v28, v23 row_newbcast:1 row_mask:0xf bank_mask:0xf
    v_and_b32_dpp v36, v28, v20 row_newbcast:9 row_mask:0xf bank_mask:0xf
    v_and_b32_dpp v37, v28, v21 row_newbcast:9 row_mask:0xf bank_mask:0xf
    v_and_b32_dpp v38, v28, v22 row_newbcast:9 row_mask:0xf bank_mask:0xf
    v_and_b32_dpp v39, v28, v23 row_newbcast:9 row_mask:0xf bank_mask:0xf
    v_and_b32_dpp v40, v28, v20 row_newbcast:5 row_mask:0xf bank_mask:0xf
    v_and_b32_dpp v41, v28, v21 row_newbcast:5 row_mask:0xf bank_mask:0xf
    v_and_b32_dpp v42, v28, v22 row_newbcast:5 row_mask:0xf bank_mask:0xf
    v_and_b32_dpp v43, v28, v23 row_newbcast:5 row_mask:0xf bank_mask:0xf
    v_and_b32_dpp v44, v28, v20 row_newbcast:13 row_mask:0xf bank_mask:0xf
    v_and_b32_dpp v45, v28, v21 row_newbcast:13 row_mask:0xf bank_mask:0xf
    v_and_b32_dpp v46, v28, v22 row_newbcast:13 row_mask:0xf bank_mask:0xf
    v_and_b32_dpp v47, v28, v23 row_newbcast:13 row_mask:0xf bank_mask:0xf
    s_waitcnt vmcnt(3)
    s_cbranch_vccnz L_sh_47
    s_waitcnt vmcnt(2)
L_sh_47:
    s_mov_b32 s56, 327680
    buffer_load_dwordx4 v[136:139], v4, s[36:39], s56 offen nt
    s_waitcnt vmcnt(3)
    s_cbranch_vccnz L_sh_48
    s_waitcnt vmcnt(2)
L_sh_48:
    buffer_load_dwordx4 v[140:143], v4, s[36:39], s56 offen offset:1024 nt
    s_waitcnt vmcnt(3)
    s_cbranch_vccnz L_sh_49
    s_waitcnt vmcnt(2)
L_sh_49:
    buffer_load_dwordx4 v[144:147], v4, s[36:39], s56 offen offset:2048 nt
    s_waitcnt vmcnt(3)
    s_cbranch_vccnz L_sh_50
    s_waitcnt vmcnt(2)
L_sh_50:
    buffer_load_dwordx4 v[148:151], v4, s[36:39], s56 offen offset:3072 nt
    ds_read_b32 v55, v14 offset:30976
    s_nop 1
    v_mfma_f32_16x16x32_bf16 v[24:27], v[32:35], v[120:123], v[24:27]
    v_mfma_f32_16x16x32_bf16 v[24:27], v[36:39], v[124:127], v[24:27]
    v_mfma_f32_16x16x32_bf16 v[24:27], v[40:43], v[128:131], v[24:27]
    v_mfma_f32_16x16x32_bf16 v[24:27], v[44:47], v[132:135], v[24:27]
    s_waitcnt lgkmcnt(0)
    v_readfirstlane_b32 s57, v55
    s_nop 3
    s_cmp_lg_u32 s57, 0
    s_cselect_b64 vcc, -1, 0
    s_cmp_lg_u32 s30, 0
    s_cbranch_scc1 L_fw_51
    s_waitcnt lgkmcnt(0)
    s_cmp_ge_u32 s3, 5
    s_cselect_b32 s57, 1, 0
    v_mov_b32 v55, s57
    ds_write_b32 v14, v55 offset:30976
L_fw_51:
    v_and_b32_dpp v32, v28, v20 row_newbcast:3 row_mask:0xf bank_mask:0xf
    v_and_b32_dpp v33, v28, v21 row_newbcast:3 row_mask:0xf bank_mask:0xf
    v_and_b32_dpp v34, v28, v22 row_newbcast:3 row_mask:0xf bank_mask:0xf
    v_and_b32_dpp v35, v28, v23 row_newbcast:3 row_mask:0xf bank_mask:0xf
    v_and_b32_dpp v36, v28, v20 row_newbcast:11 row_mask:0xf bank_mask:0xf
    v_and_b32_dpp v37, v28, v21 row_newbcast:11 row_mask:0xf bank_mask:0xf
    v_and_b32_dpp v38, v28, v22 row_newbcast:11 row_mask:0xf bank_mask:0xf
    v_and_b32_dpp v39, v28, v23 row_newbcast:11 row_mask:0xf bank_mask:0xf
    v_and_b32_dpp v40, v28, v20 row_newbcast:7 row_mask:0xf bank_mask:0xf
    v_and_b32_dpp v41, v28, v21 row_newbcast:7 row_mask:0xf bank_mask:0xf
    v_and_b32_dpp v42, v28, v22 row_newbcast:7 row_mask:0xf bank_mask:0xf
    v_and_b32_dpp v43, v28, v23 row_newbcast:7 row_mask:0xf bank_mask:0xf
    v_and_b32_dpp v44, v28, v20 row_newbcast:15 row_mask:0xf bank_mask:0xf
    v_and_b32_dpp v45, v28, v21 row_newbcast:15 row_mask:0xf bank_mask:0xf
    v_and_b32_dpp v46, v28, v22 row_newbcast:15 row_mask:0xf bank_mask:0xf
    v_and_b32_dpp v47, v28, v23 row_newbcast:15 row_mask:0xf bank_mask:0xf
    s_waitcnt vmcnt(3)
    s_cbranch_vccnz L_sh_52
    s_waitcnt vmcnt(2)
L_sh_52:
    s_mov_b32 s56, 524288
    buffer_load_dwordx4 v[152:155], v15, s[36:39], s56 offen nt
    s_waitcnt vmcnt(3)
    s_cbranch_vccnz L_sh_53
    s_waitcnt vmcnt(2)
L_sh_53:
    buffer_load_dwordx4 v[156:159], v15, s[36:39], s56 offen offset:1024 nt
    s_waitcnt vmcnt(3)
    s_cbranch_vccnz L_sh_54
    s_waitcnt vmcnt(2)
L_sh_54:
    buffer_load_dwordx4 v[160:163], v15, s[36:39], s56 offen offset:2048 nt
    s_waitcnt vmcnt(3)
    s_cbranch_vccnz L_sh_55
    s_waitcnt vmcnt(2)
L_sh_55:
    buffer_load_dwordx4 v[164:167], v15, s[36:39], s56 offen offset:3072 nt
    ds_read_b32 v55, v14 offset:30976
    s_nop 1
    v_mfma_f32_16x16x32_bf16 v[24:27], v[32:35], v[136:139], v[24:27]
    v_mfma_f32_16x16x32_bf16 v[24:27], v[36:39], v[140:143], v[24:27]
    v_mfma_f32_16x16x32_bf16 v[24:27], v[40:43], v[144:147], v[24:27]
    v_mfma_f32_16x16x32_bf16 v[24:27], v[44:47], v[148:151], v[24:27]
    s_barrier
    s_waitcnt lgkmcnt(0)
    v_readfirstlane_b32 s57, v55
    s_nop 3
    s_cmp_lg_u32 s57, 0
    s_cselect_b64 vcc, -1, 0
    v_and_b32_dpp v32, v29, v20 row_newbcast:0 row_mask:0xf bank_mask:0xf
    v_and_b32_dpp v33, v29, v21 row_newbcast:0 row_mask:0xf bank_mask:0xf
    v_and_b32_dpp v34, v29, v22 row_newbcast:0 row_mask:0xf bank_mask:0xf
    v_and_b32_dpp v35, v29, v23 row_newbcast:0 row_mask:0xf bank_mask:0xf
    v_and_b32_dpp v36, v29, v20 row_newbcast:8 row_mask:0xf bank_mask:0xf
    v_and_b32_dpp v37, v29, v21 row_newbcast:8 row_mask:0xf bank_mask:0xf
    v_and_b32_dpp v38, v29, v22 row_newbcast:8 row_mask:0xf bank_mask:0xf
    v_and_b32_dpp v39, v29, v23 row_newbcast:8 row_mask:0xf bank_mask:0xf
    v_and_b32_dpp v40, v29, v20 row_newbcast:4 row_mask:0xf bank_mask:0xf
    v_and_b32_dpp v41, v29, v21 row_newbcast:4 row_mask:0xf bank_mask:0xf
    v_and_b32_dpp v42, v29, v22 row_newbcast:4 row_mask:0xf bank_mask:0xf
    v_and_b32_dpp v43, v29, v23 row_newbcast:4 row_mask:0xf bank_mask:0xf
    v_and_b32_dpp v44, v29, v20 row_newbcast:12 row_mask:0xf bank_mask:0xf
    v_and_b32_dpp v45, v29, v21 row_newbcast:12 row_mask:0xf bank_mask:0xf
    v_and_b32_dpp v46, v29, v22 row_newbcast:12 row_mask:0xf bank_mask:0xf
    v_and_b32_dpp v47, v29, v23 row_newbcast:12 row_mask:0xf bank_mask:0xf
    s_waitcnt vmcnt(3)
    s_cbranch_vccnz L_sh_56
    s_waitcnt vmcnt(2)
L_sh_56:
    s_mov_b32 s56, 589824
    buffer_load_dwordx4 v[56:59], v15, s[36:39], s56 offen nt
    s_waitcnt vmcnt(3)
    s_cbranch_vccnz L_sh_57
    s_waitcnt vmcnt(2)
L_sh_57:
    buffer_load_dwordx4 v[60:63], v15, s[36:39], s56 offen offset:1024 nt
    s_waitcnt vmcnt(3)
    s_cbranch_vccnz L_sh_58
    s_waitcnt vmcnt(2)
L_sh_58:
    buffer_load_dwordx4 v[64:67], v15, s[36:39], s56 offen offset:2048 nt
    s_waitcnt vmcnt(3)
    s_cbranch_vccnz L_sh_59
    s_waitcnt vmcnt(2)
L_sh_59:
    buffer_load_dwordx4 v[68:71], v15, s[36:39], s56 offen offset:3072 nt
    ds_read_b32 v55, v14 offset:30976
    s_nop 1
    v_mfma_f32_16x16x32_bf16 v[24:27], v[32:35], v[152:155], v[24:27]
    v_mfma_f32_16x16x32_bf16 v[24:27], v[36:39], v[156:159], v[24:27]
    v_mfma_f32_16x16x32_bf16 v[24:27], v[40:43], v[160:163], v[24:27]
    v_mfma_f32_16x16x32_bf16 v[24:27], v[44:47], v[164:167], v[24:27]
    s_waitcnt lgkmcnt(0)
    v_readfirstlane_b32 s57, v55
    s_nop 3
    s_cmp_lg_u32 s57, 0
    s_cselect_b64 vcc, -1, 0
    s_cmp_lg_u32 s30, 0
    s_cbranch_scc1 L_fr_60
    s_waitcnt lgkmcnt(0)
    s_mov_b32 s3, 8
    s_cmp_eq_u32 s70, 0
    s_cbranch_scc1 L_nf_61
    s_mov_b32 s3, 1
    s_atomic_add s3, s[24:25], s61 glc
L_nf_61:
    s_add_u32 s61, s61, 8192
L_fr_60:
    v_and_b32_dpp v32, v29, v20 row_newbcast:2 row_mask:0xf bank_mask:0xf
    v_and_b32_dpp v33, v29, v21 row_newbcast:2 row_mask:0xf bank_mask:0xf
    v_and_b32_dpp v34, v29, v22 row_newbcast:2 row_mask:0xf bank_mask:0xf
    v_and_b32_dpp v35, v29, v23 row_newbcast:2 row_mask:0xf bank_mask:0xf
    v_and_b32_dpp v36, v29, v20 row_newbcast:10 row_mask:0xf bank_mask:0xf
    v_and_b32_dpp v37, v29, v21 row_newbcast:10 row_mask:0xf bank_mask:0xf
    v_and_b32_dpp v38, v29, v22 row_newbcast:10 row_mask:0xf bank_mask:0xf
    v_and_b32_dpp v39, v29, v23 row_newbcast:10 row_mask:0xf bank_mask:0xf
    v_and_b32_dpp v40, v29, v20 row_newbcast:6 row_mask:0xf bank_mask:0xf
    v_and_b32_dpp v41, v29, v21 row_newbcast:6 row_mask:0xf bank_mask:0xf
    v_and_b32_dpp v42, v29, v22 row_newbcast:6 row_mask:0xf bank_mask:0xf
    v_and_b32_dpp v43, v29, v23 row_newbcast:6 row_mask:0xf bank_mask:0xf
    v_and_b32_dpp v44, v29, v20 row_newbcast:14 row_mask:0xf bank_mask:0xf
    v_and_b32_dpp v45, v29, v21 row_newbcast:14 row_mask:0xf bank_mask:0xf
    v_and_b32_dpp v46, v29, v22 row_newbcast:14 row_mask:0xf bank_mask:0xf
    v_and_b32_dpp v47, v29, v23 row_newbcast:14 row_mask:0xf bank_mask:0xf
    s_waitcnt vmcnt(3)
    s_cbranch_vccnz L_sh_62
    s_waitcnt vmcnt(2)
L_sh_62:
    s_mov_b32 s56, 786432
    buffer_load_dwordx4 v[72:75], v15, s[36:39], s56 offen nt
    s_waitcnt vmcnt(3)
    s_cbranch_vccnz L_sh_63
    s_waitcnt vmcnt(2)
L_sh_63:
    buffer_load_dwordx4 v[76:79], v15, s[36:39], s56 offen offset:1024 nt
    s_waitcnt vmcnt(3)
    s_cbranch_vccnz L_sh_64
    s_waitcnt vmcnt(2)
L_sh_64:
    buffer_load_dwordx4 v[80:83], v15, s[36:39], s56 offen offset:2048 nt
    s_waitcnt vmcnt(3)
    s_cbranch_vccnz L_sh_65
    s_waitcnt vmcnt(2)
L_sh_65:
    buffer_load_dwordx4 v[84:87], v15, s[36:39], s56 offen offset:3072 nt
    ds_read_b32 v55, v14 offset:30976
    s_nop 1
    v_mfma_f32_16x16x32_bf16 v[24:27], v[32:35], v[56:59], v[24:27]
    v_mfma_f32_16x16x32_bf16 v[24:27], v[36:39], v[60:63], v[24:27]
    v_mfma_f32_16x16x32_bf16 v[24:27], v[40:43], v[64:67], v[24:27]
    v_mfma_f32_16x16x32_bf16 v[24:27], v[44:47], v[68:71], v[24:27]
    s_barrier
    s_waitcnt lgkmcnt(0)
    v_readfirstlane_b32 s57, v55
    s_nop 3
    s_cmp_lg_u32 s57, 0
    s_cselect_b64 vcc, -1, 0
    s_cmp_lg_u32 s30, 0
    s_cbranch_scc1 L_fw_66
    s_waitcnt lgkmcnt(0)
    s_cmp_ge_u32 s3, 5
    s_cselect_b32 s57, 1, 0
    v_mov_b32 v55, s57
    ds_write_b32 v14, v55 offset:30976
L_fw_66:
    v_and_b32_dpp v32, v29, v20 row_newbcast:1 row_mask:0xf bank_mask:0xf
    v_and_b32_dpp v33, v29, v21 row_newbcast:1 row_mask:0xf bank_mask:0xf
    v_and_b32_dpp v34, v29, v22 row_newbcast:1 row_mask:0xf bank_mask:0xf
    v_and_b32_dpp v35, v29, v23 row_newbcast:1 row_mask:0xf bank_mask:0xf
    v_and_b32_dpp v36, v29, v20 row_newbcast:9 row_mask:0xf bank_mask:0xf
    v_and_b32_dpp v37, v29, v21 row_newbcast:9 row_mask:0xf bank_mask:0xf
    v_and_b32_dpp v38, v29, v22 row_newbcast:9 row_mask:0xf bank_mask:0xf
    v_and_b32_dpp v39, v29, v23 row_newbcast:9 row_mask:0xf bank_mask:0xf
    v_and_b32_dpp v40, v29, v20 row_newbcast:5 row_mask:0xf bank_mask:0xf
    v_and_b32_dpp v41, v29, v21 row_newbcast:5 row_mask:0xf bank_mask:0xf
    v_and_b32_dpp v42, v29, v22 row_newbcast:5 row_mask:0xf bank_mask:0xf
    v_and_b32_dpp v43, v29, v23 row_newbcast:5 row_mask:0xf bank_mask:0xf
    v_and_b32_dpp v44, v29, v20 row_newbcast:13 row_mask:0xf bank_mask:0xf
    v_and_b32_dpp v45, v29, v21 row_newbcast:13 row_mask:0xf bank_mask:0xf
    v_and_b32_dpp v46, v29, v22 row_newbcast:13 row_mask:0xf bank_mask:0xf
    v_and_b32_dpp v47, v29, v23 row_newbcast:13 row_mask:0xf bank_mask:0xf
    s_waitcnt vmcnt(3)
    s_cbranch_vccnz L_sh_67
    s_waitcnt vmcnt(2)
L_sh_67:
    s_mov_b32 s56, 851968
    buffer_load_dwordx4 v[88:91], v15, s[36:39], s56 offen nt
    s_waitcnt vmcnt(3)
    s_cbranch_vccnz L_sh_68
    s_waitcnt vmcnt(2)
L_sh_68:
    buffer_load_dwordx4 v[92:95], v15, s[36:39], s56 offen offset:1024 nt
    s_waitcnt vmcnt(3)
    s_cbranch_vccnz L_sh_69
    s_waitcnt vmcnt(2)
L_sh_69:
    buffer_load_dwordx4 v[96:99], v15, s[36:39], s56 offen offset:2048 nt
    s_waitcnt vmcnt(3)
    s_cbranch_vccnz L_sh_70
    s_waitcnt vmcnt(2)
L_sh_70:
    buffer_load_dwordx4 v[100:103], v15, s[36:39], s56 offen offset:3072 nt
    ds_read_b32 v55, v14 offset:30976
    s_nop 1
    v_mfma_f32_16x16x32_bf16 v[24:27], v[32:35], v[72:75], v[24:27]
    v_mfma_f32_16x16x32_bf16 v[24:27], v[36:39], v[76:79], v[24:27]
    v_mfma_f32_16x16x32_bf16 v[24:27], v[40:43], v[80:83], v[24:27]
    v_mfma_f32_16x16x32_bf16 v[24:27], v[44:47], v[84:87], v[24:27]
    s_waitcnt lgkmcnt(0)
    v_readfirstlane_b32 s57, v55
    s_nop 3
    s_cmp_lg_u32 s57, 0
    s_cselect_b64 vcc, -1, 0
    v_and_b32_dpp v32, v29, v20 row_newbcast:3 row_mask:0xf bank_mask:0xf
    v_and_b32_dpp v33, v29, v21 row_newbcast:3 row_mask:0xf bank_mask:0xf
    v_and_b32_dpp v34, v29, v22 row_newbcast:3 row_mask:0xf bank_mask:0xf
    v_and_b32_dpp v35, v29, v23 row_newbcast:3 row_mask:0xf bank_mask:0xf
    v_and_b32_dpp v36, v29, v20 row_newbcast:11 row_mask:0xf bank_mask:0xf
    v_and_b32_dpp v37, v29, v21 row_newbcast:11 row_mask:0xf bank_mask:0xf
    v_and_b32_dpp v38, v29, v22 row_newbcast:11 row_mask:0xf bank_mask:0xf
    v_and_b32_dpp v39, v29, v23 row_newbcast:11 row_mask:0xf bank_mask:0xf
    v_and_b32_dpp v40, v29, v20 row_newbcast:7 row_mask:0xf bank_mask:0xf
    v_and_b32_dpp v41, v29, v21 row_newbcast:7 row_mask:0xf bank_mask:0xf
    v_and_b32_dpp v42, v29, v22 row_newbcast:7 row_mask:0xf bank_mask:0xf
    v_and_b32_dpp v43, v29, v23 row_newbcast:7 row_mask:0xf bank_mask:0xf
    v_and_b32_dpp v44, v29, v20 row_newbcast:15 row_mask:0xf bank_mask:0xf
    v_and_b32_dpp v45, v29, v21 row_newbcast:15 row_mask:0xf bank_mask:0xf
    v_and_b32_dpp v46, v29, v22 row_newbcast:15 row_mask:0xf bank_mask:0xf
    v_and_b32_dpp v47, v29, v23 row_newbcast:15 row_mask:0xf bank_mask:0xf
    s_waitcnt vmcnt(3)
    s_cbranch_vccnz L_sh_71
    s_waitcnt vmcnt(2)
L_sh_71:
    s_mov_b32 s56, 131072
    buffer_load_dwordx4 v[104:107], v4, s[36:39], s56 offen nt
    s_waitcnt vmcnt(3)
    s_cbranch_vccnz L_sh_72
    s_waitcnt vmcnt(2)
L_sh_72:
    buffer_load_dwordx4 v[108:111], v4, s[36:39], s56 offen offset:1024 nt
    s_waitcnt vmcnt(3)
    s_cbranch_vccnz L_sh_73
    s_waitcnt vmcnt(2)
L_sh_73:
    buffer_load_dwordx4 v[112:115], v4, s[36:39], s56 offen offset:2048 nt
    s_waitcnt vmcnt(3)
    s_cbranch_vccnz L_sh_74
    s_waitcnt vmcnt(2)
L_sh_74:
    buffer_load_dwordx4 v[116:119], v4, s[36:39], s56 offen offset:3072 nt
    ds_read_b32 v55, v14 offset:30976
    s_nop 1
    v_mfma_f32_16x16x32_bf16 v[24:27], v[32:35], v[88:91], v[24:27]
    v_mfma_f32_16x16x32_bf16 v[24:27], v[36:39], v[92:95], v[24:27]
    v_mfma_f32_16x16x32_bf16 v[24:27], v[40:43], v[96:99], v[24:27]
    v_mfma_f32_16x16x32_bf16 v[24:27], v[44:47], v[100:103], v[24:27]
    s_barrier
    s_waitcnt lgkmcnt(0)
    v_readfirstlane_b32 s57, v55
    s_nop 3
    s_cmp_lg_u32 s57, 0
    s_cselect_b64 vcc, -1, 0
    s_cmp_lg_u32 s30, 0
    s_cbranch_scc1 L_fr_75
    s_waitcnt lgkmcnt(0)
    s_mov_b32 s3, 8
    s_cmp_eq_u32 s70, 0
    s_cbranch_scc1 L_nf_76
    s_mov_b32 s3, 1
    s_atomic_add s3, s[24:25], s61 glc
L_nf_76:
    s_add_u32 s61, s61, 8192
L_fr_75:
    v_and_b32_dpp v32, v30, v20 row_newbcast:0 row_mask:0xf bank_mask:0xf
    v_and_b32_dpp v33, v30, v21 row_newbcast:0 row_mask:0xf bank_mask:0xf
    v_and_b32_dpp v34, v30, v22 row_newbcast:0 row_mask:0xf bank_mask:0xf
    v_and_b32_dpp v35, v30, v23 row_newbcast:0 row_mask:0xf bank_mask:0xf
    v_and_b32_dpp v36, v30, v20 row_newbcast:8 row_mask:0xf bank_mask:0xf
    v_and_b32_dpp v37, v30, v21 row_newbcast:8 row_mask:0xf bank_mask:0xf
    v_and_b32_dpp v38, v30, v22 row_newbcast:8 row_mask:0xf bank_mask:0xf
    v_and_b32_dpp v39, v30, v23 row_newbcast:8 row_mask:0xf bank_mask:0xf
    v_and_b32_dpp v40, v30, v20 row_newbcast:4 row_mask:0xf bank_mask:0xf
    v_and_b32_dpp v41, v30, v21 row_newbcast:4 row_mask:0xf bank_mask:0xf
    v_and_b32_dpp v42, v30, v22 row_newbcast:4 row_mask:0xf bank_mask:0xf
    v_and_b32_dpp v43, v30, v23 row_newbcast:4 row_mask:0xf bank_mask:0xf
    v_and_b32_dpp v44, v30, v20 row_newbcast:12 row_mask:0xf bank_mask:0xf
    v_and_b32_dpp v45, v30, v21 row_newbcast:12 row_mask:0xf bank_mask:0xf
    v_and_b32_dpp v46, v30, v22 row_newbcast:12 row_mask:0xf bank_mask:0xf
    v_and_b32_dpp v47, v30, v23 row_newbcast:12 row_mask:0xf bank_mask:0xf
    s_waitcnt vmcnt(3)
    s_cbranch_vccnz L_sh_77
    s_waitcnt vmcnt(2)
L_sh_77:
    s_mov_b32 s56, 196608
    buffer_load_dwordx4 v[120:123], v4, s[36:39], s56 offen nt
    s_waitcnt vmcnt(3)
    s_cbranch_vccnz L_sh_78
    s_waitcnt vmcnt(2)
L_sh_78:
    buffer_load_dwordx4 v[124:127], v4, s[36:39], s56 offen offset:1024 nt
    s_waitcnt vmcnt(3)
    s_cbranch_vccnz L_sh_79
    s_waitcnt vmcnt(2)
L_sh_79:
    buffer_load_dwordx4 v[128:131], v4, s[36:39], s56 offen offset:2048 nt
    s_waitcnt vmcnt(3)
    s_cbranch_vccnz L_sh_80
    s_waitcnt vmcnt(2)
L_sh_80:
    buffer_load_dwordx4 v[132:135], v4, s[36:39], s56 offen offset:3072 nt
    ds_read_b32 v55, v14 offset:30976
    s_nop 1
    v_mfma_f32_16x16x32_bf16 v[24:27], v[32:35], v[104:107], v[24:27]
    v_mfma_f32_16x16x32_bf16 v[24:27], v[36:39], v[108:111], v[24:27]
    v_mfma_f32_16x16x32_bf16 v[24:27], v[40:43], v[112:115], v[24:27]
    v_mfma_f32_16x16x32_bf16 v[24:27], v[44:47], v[116:119], v[24:27]
    s_waitcnt lgkmcnt(0)
    v_readfirstlane_b32 s57, v55
    s_nop 3
    s_cmp_lg_u32 s57, 0
    s_cselect_b64 vcc, -1, 0
    s_cmp_lg_u32 s30, 0
    s_cbranch_scc1 L_fw_81
    s_waitcnt lgkmcnt(0)
    s_cmp_ge_u32 s3, 5
    s_cselect_b32 s57, 1, 0
    v_mov_b32 v55, s57
    ds_write_b32 v14, v55 offset:30976
L_fw_81:
    v_and_b32_dpp v32, v30, v20 row_newbcast:2 row_mask:0xf bank_mask:0xf
    v_and_b32_dpp v33, v30, v21 row_newbcast:2 row_mask:0xf bank_mask:0xf
    v_and_b32_dpp v34, v30, v22 row_newbcast:2 row_mask:0xf bank_mask:0xf
    v_and_b32_dpp v35, v30, v23 row_newbcast:2 row_mask:0xf bank_mask:0xf
    v_and_b32_dpp v36, v30, v20 row_newbcast:10 row_mask:0xf bank_mask:0xf
    v_and_b32_dpp v37, v30, v21 row_newbcast:10 row_mask:0xf bank_mask:0xf
    v_and_b32_dpp v38, v30, v22 row_newbcast:10 row_mask:0xf bank_mask:0xf
    v_and_b32_dpp v39, v30, v23 row_newbcast:10 row_mask:0xf bank_mask:0xf
    v_and_b32_dpp v40, v30, v20 row_newbcast:6 row_mask:0xf bank_mask:0xf
    v_and_b32_dpp v41, v30, v21 row_newbcast:6 row_mask:0xf bank_mask:0xf
    v_and_b32_dpp v42, v30, v22 row_newbcast:6 row_mask:0xf bank_mask:0xf
    v_and_b32_dpp v43, v30, v23 row_newbcast:6 row_mask:0xf bank_mask:0xf
    v_and_b32_dpp v44, v30, v20 row_newbcast:14 row_mask:0xf bank_mask:0xf
    v_and_b32_dpp v45, v30, v21 row_newbcast:14 row_mask:0xf bank_mask:0xf
    v_and_b32_dpp v46, v30, v22 row_newbcast:14 row_mask:0xf bank_mask:0xf
    v_and_b32_dpp v47, v30, v23 row_newbcast:14 row_mask:0xf bank_mask:0xf
    s_waitcnt vmcnt(3)
    s_cbranch_vccnz L_sh_82
    s_waitcnt vmcnt(2)
L_sh_82:
    s_mov_b32 s56, 393216
    buffer_load_dwordx4 v[136:139], v4, s[36:39], s56 offen nt
    s_waitcnt vmcnt(3)
    s_cbranch_vccnz L_sh_83
    s_waitcnt vmcnt(2)
L_sh_83:
    buffer_load_dwordx4 v[140:143], v4, s[36:39], s56 offen offset:1024 nt
    s_waitcnt vmcnt(3)
    s_cbranch_vccnz L_sh_84
    s_waitcnt vmcnt(2)
L_sh_84:
    buffer_load_dwordx4 v[144:147], v4, s[36:39], s56 offen offset:2048 nt
    s_waitcnt vmcnt(3)
    s_cbranch_vccnz L_sh_85
    s_waitcnt vmcnt(2)
L_sh_85:
    buffer_load_dwordx4 v[148:151], v4, s[36:39], s56 offen offset:3072 nt
    ds_read_b32 v55, v14 offset:30976
    s_nop 1
    v_mfma_f32_16x16x32_bf16 v[24:27], v[32:35], v[120:123], v[24:27]
    v_mfma_f32_16x16x32_bf16 v[24:27], v[36:39], v[124:127], v[24:27]
    v_mfma_f32_16x16x32_bf16 v[24:27], v[40:43], v[128:131], v[24:27]
    v_mfma_f32_16x16x32_bf16 v[24:27], v[44:47], v[132:135], v[24:27]
    s_barrier
    s_waitcnt lgkmcnt(0)
    v_readfirstlane_b32 s57, v55
    s_nop 3
    s_cmp_lg_u32 s57, 0
    s_cselect_b64 vcc, -1, 0
    v_and_b32_dpp v32, v30, v20 row_newbcast:1 row_mask:0xf bank_mask:0xf
    v_and_b32_dpp v33, v30, v21 row_newbcast:1 row_mask:0xf bank_mask:0xf
    v_and_b32_dpp v34, v30, v22 row_newbcast:1 row_mask:0xf bank_mask:0xf
    v_and_b32_dpp v35, v30, v23 row_newbcast:1 row_mask:0xf bank_mask:0xf
    v_and_b32_dpp v36, v30, v20 row_newbcast:9 row_mask:0xf bank_mask:0xf
    v_and_b32_dpp v37, v30, v21 row_newbcast:9 row_mask:0xf bank_mask:0xf
    v_and_b32_dpp v38, v30, v22 row_newbcast:9 row_mask:0xf bank_mask:0xf
    v_and_b32_dpp v39, v30, v23 row_newbcast:9 row_mask:0xf bank_mask:0xf
    v_and_b32_dpp v40, v30, v20 row_newbcast:5 row_mask:0xf bank_mask:0xf
    v_and_b32_dpp v41, v30, v21 row_newbcast:5 row_mask:0xf bank_mask:0xf
    v_and_b32_dpp v42, v30, v22 row_newbcast:5 row_mask:0xf bank_mask:0xf
    v_and_b32_dpp v43, v30, v23 row_newbcast:5 row_mask:0xf bank_mask:0xf
    v_and_b32_dpp v44, v30, v20 row_newbcast:13 row_mask:0xf bank_mask:0xf
    v_and_b32_dpp v45, v30, v21 row_newbcast:13 row_mask:0xf bank_mask:0xf
    v_and_b32_dpp v46, v30, v22 row_newbcast:13 row_mask:0xf bank_mask:0xf
    v_and_b32_dpp v47, v30, v23 row_newbcast:13 row_mask:0xf bank_mask:0xf
    s_waitcnt vmcnt(3)
    s_cbranch_vccnz L_sh_86
    s_waitcnt vmcnt(2)
L_sh_86:
    s_mov_b32 s56, 458752
    buffer_load_dwordx4 v[152:155], v4, s[36:39], s56 offen nt
    s_waitcnt vmcnt(3)
    s_cbranch_vccnz L_sh_87
    s_waitcnt vmcnt(2)
L_sh_87:
    buffer_load_dwordx4 v[156:159], v4, s[36:39], s56 offen offset:1024 nt
    s_waitcnt vmcnt(3)
    s_cbranch_vccnz L_sh_88
    s_waitcnt vmcnt(2)
L_sh_88:
    buffer_load_dwordx4 v[160:163], v4, s[36:39], s56 offen offset:2048 nt
    s_waitcnt vmcnt(3)
    s_cbranch_vccnz L_sh_89
    s_waitcnt vmcnt(2)
L_sh_89:
    buffer_load_dwordx4 v[164:167], v4, s[36:39], s56 offen offset:3072 nt
    ds_read_b32 v55, v14 offset:30976
    s_nop 1
    v_mfma_f32_16x16x32_bf16 v[24:27], v[32:35], v[136:139], v[24:27]
    v_mfma_f32_16x16x32_bf16 v[24:27], v[36:39], v[140:143], v[24:27]
    v_mfma_f32_16x16x32_bf16 v[24:27], v[40:43], v[144:147], v[24:27]
    v_mfma_f32_16x16x32_bf16 v[24:27], v[44:47], v[148:151], v[24:27]
    s_waitcnt lgkmcnt(0)
    v_readfirstlane_b32 s57, v55
    s_nop 3
    s_cmp_lg_u32 s57, 0
    s_cselect_b64 vcc, -1, 0
    s_cmp_lg_u32 s30, 0
    s_cbranch_scc1 L_fr_90
    s_waitcnt lgkmcnt(0)
    s_mov_b32 s3, 8
    s_cmp_eq_u32 s70, 0
    s_cbranch_scc1 L_nf_91
    s_mov_b32 s3, 1
    s_atomic_add s3, s[24:25], s61 glc
L_nf_91:
    s_add_u32 s61, s61, 8192
L_fr_90:
    v_and_b32_dpp v32, v30, v20 row_newbcast:3 row_mask:0xf bank_mask:0xf
    v_and_b32_dpp v33, v30, v21 row_newbcast:3 row_mask:0xf bank_mask:0xf
    v_and_b32_dpp v34, v30, v22 row_newbcast:3 row_mask:0xf bank_mask:0xf
    v_and_b32_dpp v35, v30, v23 row_newbcast:3 row_mask:0xf bank_mask:0xf
    v_and_b32_dpp v36, v30, v20 row_newbcast:11 row_mask:0xf bank_mask:0xf
    v_and_b32_dpp v37, v30, v21 row_newbcast:11 row_mask:0xf bank_mask:0xf
    v_and_b32_dpp v38, v30, v22 row_newbcast:11 row_mask:0xf bank_mask:0xf
    v_and_b32_dpp v39, v30, v23 row_newbcast:11 row_mask:0xf bank_mask:0xf
    v_and_b32_dpp v40, v30, v20 row_newbcast:7 row_mask:0xf bank_mask:0xf
    v_and_b32_dpp v41, v30, v21 row_newbcast:7 row_mask:0xf bank_mask:0xf
    v_and_b32_dpp v42, v30, v22 row_newbcast:7 row_mask:0xf bank_mask:0xf
    v_and_b32_dpp v43, v30, v23 row_newbcast:7 row_mask:0xf bank_mask:0xf
    v_and_b32_dpp v44, v30, v20 row_newbcast:15 row_mask:0xf bank_mask:0xf
    v_and_b32_dpp v45, v30, v21 row_newbcast:15 row_mask:0xf bank_mask:0xf
    v_and_b32_dpp v46, v30, v22 row_newbcast:15 row_mask:0xf bank_mask:0xf
    v_and_b32_dpp v47, v30, v23 row_newbcast:15 row_mask:0xf bank_mask:0xf
    s_waitcnt vmcnt(3)
    s_cbranch_vccnz L_sh_92
    s_waitcnt vmcnt(2)
L_sh_92:
    s_mov_b32 s56, 655360
    buffer_load_dwordx4 v[56:59], v15, s[36:39], s56 offen nt
    s_waitcnt vmcnt(3)
    s_cbranch_vccnz L_sh_93
    s_waitcnt vmcnt(2)
L_sh_93:
    buffer_load_dwordx4 v[60:63], v15, s[36:39], s56 offen offset:1024 nt
    s_waitcnt vmcnt(3)
    s_cbranch_vccnz L_sh_94
    s_waitcnt vmcnt(2)
L_sh_94:
    buffer_load_dwordx4 v[64:67], v15, s[36:39], s56 offen offset:2048 nt
    s_waitcnt vmcnt(3)
    s_cbranch_vccnz L_sh_95
    s_waitcnt vmcnt(2)
L_sh_95:
    buffer_load_dwordx4 v[68:71], v15, s[36:39], s56 offen offset:3072 nt
    ds_read_b32 v55, v14 offset:30976
    s_nop 1
    v_mfma_f32_16x16x32_bf16 v[24:27], v[32:35], v[152:155], v[24:27]
    v_mfma_f32_16x16x32_bf16 v[24:27], v[36:39], v[156:159], v[24:27]
    v_mfma_f32_16x16x32_bf16 v[24:27], v[40:43], v[160:163], v[24:27]
    v_mfma_f32_16x16x32_bf16 v[24:27], v[44:47], v[164:167], v[24:27]
    s_barrier
    s_waitcnt lgkmcnt(0)
    v_readfirstlane_b32 s57, v55
    s_nop 3
    s_cmp_lg_u32 s57, 0
    s_cselect_b64 vcc, -1, 0
    s_cmp_lg_u32 s30, 0
    s_cbranch_scc1 L_fw_96
    s_waitcnt lgkmcnt(0)
    s_cmp_ge_u32 s3, 5
    s_cselect_b32 s57, 1, 0
    v_mov_b32 v55, s57
    ds_write_b32 v14, v55 offset:30976
L_fw_96:
    s_cmp_lg_u32 s30, 0
    s_cbranch_scc1 L_ldp_97
    s_waitcnt lgkmcnt(0)
    s_xor_b32 s62, s62, 128
    s_load_dword s7, s[24:25], s62 glc
L_ldp_97:
    v_and_b32_dpp v32, v31, v20 row_newbcast:0 row_mask:0xf bank_mask:0xf
    v_and_b32_dpp v33, v31, v21 row_newbcast:0 row_mask:0xf bank_mask:0xf
    v_and_b32_dpp v34, v31, v22 row_newbcast:0 row_mask:0xf bank_mask:0xf
    v_and_b32_dpp v35, v31, v23 row_newbcast:0 row_mask:0xf bank_mask:0xf
    v_and_b32_dpp v36, v31, v20 row_newbcast:8 row_mask:0xf bank_mask:0xf
    v_and_b32_dpp v37, v31, v21 row_newbcast:8 row_mask:0xf bank_mask:0xf
    v_and_b32_dpp v38, v31, v22 row_newbcast:8 row_mask:0xf bank_mask:0xf
    v_and_b32_dpp v39, v31, v23 row_newbcast:8 row_mask:0xf bank_mask:0xf
    v_and_b32_dpp v40, v31, v20 row_newbcast:4 row_mask:0xf bank_mask:0xf
    v_and_b32_dpp v41, v31, v21 row_newbcast:4 row_mask:0xf bank_mask:0xf
    v_and_b32_dpp v42, v31, v22 row_newbcast:4 row_mask:0xf bank_mask:0xf
    v_and_b32_dpp v43, v31, v23 row_newbcast:4 row_mask:0xf bank_mask:0xf
    v_and_b32_dpp v44, v31, v20 row_newbcast:12 row_mask:0xf bank_mask:0xf
    v_and_b32_dpp v45, v31, v21 row_newbcast:12 row_mask:0xf bank_mask:0xf
    v_and_b32_dpp v46, v31, v22 row_newbcast:12 row_mask:0xf bank_mask:0xf
    v_and_b32_dpp v47, v31, v23 row_newbcast:12 row_mask:0xf bank_mask:0xf
    s_waitcnt vmcnt(3)
    s_cbranch_vccnz L_sh_98
    s_waitcnt vmcnt(2)
L_sh_98:
    s_mov_b32 s56, 720896
    buffer_load_dwordx4 v[72:75], v15, s[36:39], s56 offen nt
    s_waitcnt vmcnt(3)
    s_cbranch_vccnz L_sh_99
    s_waitcnt vmcnt(2)
L_sh_99:
    buffer_load_dwordx4 v[76:79], v15, s[36:39], s56 offen offset:1024 nt
    s_waitcnt vmcnt(3)
    s_cbranch_vccnz L_sh_100
    s_waitcnt vmcnt(2)
L_sh_100:
    buffer_load_dwordx4 v[80:83], v15, s[36:39], s56 offen offset:2048 nt
    s_waitcnt vmcnt(3)
    s_cbranch_vccnz L_sh_101
    s_waitcnt vmcnt(2)
L_sh_101:
    buffer_load_dwordx4 v[84:87], v15, s[36:39], s56 offen offset:3072 nt
    ds_read_b32 v55, v14 offset:30976
    s_nop 1
    v_mfma_f32_16x16x32_bf16 v[24:27], v[32:35], v[56:59], v[24:27]
    v_mfma_f32_16x16x32_bf16 v[24:27], v[36:39], v[60:63], v[24:27]
    v_mfma_f32_16x16x32_bf16 v[24:27], v[40:43], v[64:67], v[24:27]
    v_mfma_f32_16x16x32_bf16 v[24:27], v[44:47], v[68:71], v[24:27]
    s_waitcnt lgkmcnt(0)
    v_readfirstlane_b32 s57, v55
    s_nop 3
    s_cmp_lg_u32 s57, 0
    s_cselect_b64 vcc, -1, 0
    v_and_b32_dpp v32, v31, v20 row_newbcast:2 row_mask:0xf bank_mask:0xf
    v_and_b32_dpp v33, v31, v21 row_newbcast:2 row_mask:0xf bank_mask:0xf
    v_and_b32_dpp v34, v31, v22 row_newbcast:2 row_mask:0xf bank_mask:0xf
    v_and_b32_dpp v35, v31, v23 row_newbcast:2 row_mask:0xf bank_mask:0xf
    v_and_b32_dpp v36, v31, v20 row_newbcast:10 row_mask:0xf bank_mask:0xf
    v_and_b32_dpp v37, v31, v21 row_newbcast:10 row_mask:0xf bank_mask:0xf
    v_and_b32_dpp v38, v31, v22 row_newbcast:10 row_mask:0xf bank_mask:0xf
    v_and_b32_dpp v39, v31, v23 row_newbcast:10 row_mask:0xf bank_mask:0xf
    v_and_b32_dpp v40, v31, v20 row_newbcast:6 row_mask:0xf bank_mask:0xf
    v_and_b32_dpp v41, v31, v21 row_newbcast:6 row_mask:0xf bank_mask:0xf
    v_and_b32_dpp v42, v31, v22 row_newbcast:6 row_mask:0xf bank_mask:0xf
    v_and_b32_dpp v43, v31, v23 row_newbcast:6 row_mask:0xf bank_mask:0xf
    v_and_b32_dpp v44, v31, v20 row_newbcast:14 row_mask:0xf bank_mask:0xf
    v_and_b32_dpp v45, v31, v21 row_newbcast:14 row_mask:0xf bank_mask:0xf
    v_and_b32_dpp v46, v31, v22 row_newbcast:14 row_mask:0xf bank_mask:0xf
    v_and_b32_dpp v47, v31, v23 row_newbcast:14 row_mask:0xf bank_mask:0xf
    s_waitcnt vmcnt(3)
    s_cbranch_vccnz L_sh_102
    s_waitcnt vmcnt(2)
L_sh_102:
    s_mov_b32 s56, 917504
    buffer_load_dwordx4 v[88:91], v15, s[36:39], s56 offen nt
    s_waitcnt vmcnt(3)
    s_cbranch_vccnz L_sh_103
    s_waitcnt vmcnt(2)
L_sh_103:
    buffer_load_dwordx4 v[92:95], v15, s[36:39], s56 offen offset:1024 nt
    s_waitcnt vmcnt(3)
    s_cbranch_vccnz L_sh_104
    s_waitcnt vmcnt(2)
L_sh_104:
    buffer_load_dwordx4 v[96:99], v15, s[36:39], s56 offen offset:2048 nt
    s_waitcnt vmcnt(3)
    s_cbranch_vccnz L_sh_105
    s_waitcnt vmcnt(2)
L_sh_105:
    buffer_load_dwordx4 v[100:103], v15, s[36:39], s56 offen offset:3072 nt
    ds_read_b32 v55, v14 offset:30976
    s_nop 1
    v_mfma_f32_16x16x32_bf16 v[24:27], v[32:35], v[72:75], v[24:27]
    v_mfma_f32_16x16x32_bf16 v[24:27], v[36:39], v[76:79], v[24:27]
    v_mfma_f32_16x16x32_bf16 v[24:27], v[40:43], v[80:83], v[24:27]
    v_mfma_f32_16x16x32_bf16 v[24:27], v[44:47], v[84:87], v[24:27]
    s_barrier
    s_waitcnt lgkmcnt(0)
    v_readfirstlane_b32 s57, v55
    s_nop 3
    s_cmp_lg_u32 s57, 0
    s_cselect_b64 vcc, -1, 0
    s_cmp_lg_u32 s30, 0
    s_cbranch_scc1 L_fin_106
    s_waitcnt lgkmcnt(0)
    s_cmp_lg_u32 s7, 0
    s_cbranch_scc1 L_pok_107
    s_mov_b32 s60, 0
L_psp_108:
    s_atomic_or s7, s[24:25], s62 glc
    s_add_u32 s60, s60, 1
    s_lshr_b32 s58, s60, 18
    s_waitcnt lgkmcnt(0)
    s_or_b32 s58, s58, s7
    s_cmp_eq_u32 s58, 0
    s_cbranch_scc1 L_psp_108
L_pok_107:
    s_not_b32 s7, s7
    v_mov_b32 v50, s7
    v_max_f32 v48, s6, v50
    v_sub_f32 v49, s6, v48
    v_sub_f32 v50, v50, v48
    v_sub_f32 v51, v5, v48
    v_exp_f32 v49, v49
    v_exp_f32 v50, v50
    v_exp_f32 v51, v51
    v_add_f32 v49, v49, v50
    v_rcp_f32 v49, v49
    v_mov_b32 v52, 0
    v_mul_f32 v49, v49, v51
    s_mov_b64 exec, 1
    ds_write_b32 v52, v49 offset:0
    s_mov_b64 exec, -1
L_fin_106:
    v_and_b32_dpp v32, v31, v20 row_newbcast:1 row_mask:0xf bank_mask:0xf
    v_and_b32_dpp v33, v31, v21 row_newbcast:1 row_mask:0xf bank_mask:0xf
    v_and_b32_dpp v34, v31, v22 row_newbcast:1 row_mask:0xf bank_mask:0xf
    v_and_b32_dpp v35, v31, v23 row_newbcast:1 row_mask:0xf bank_mask:0xf
    v_and_b32_dpp v36, v31, v20 row_newbcast:9 row_mask:0xf bank_mask:0xf
    v_and_b32_dpp v37, v31, v21 row_newbcast:9 row_mask:0xf bank_mask:0xf
    v_and_b32_dpp v38, v31, v22 row_newbcast:9 row_mask:0xf bank_mask:0xf
    v_and_b32_dpp v39, v31, v23 row_newbcast:9 row_mask:0xf bank_mask:0xf
    v_and_b32_dpp v40, v31, v20 row_newbcast:5 row_mask:0xf bank_mask:0xf
    v_and_b32_dpp v41, v31, v21 row_newbcast:5 row_mask:0xf bank_mask:0xf
    v_and_b32_dpp v42, v31, v22 row_newbcast:5 row_mask:0xf bank_mask:0xf
    v_and_b32_dpp v43, v31, v23 row_newbcast:5 row_mask:0xf bank_mask:0xf
    v_and_b32_dpp v44, v31, v20 row_newbcast:13 row_mask:0xf bank_mask:0xf
    v_and_b32_dpp v45, v31, v21 row_newbcast:13 row_mask:0xf bank_mask:0xf
    v_and_b32_dpp v46, v31, v22 row_newbcast:13 row_mask:0xf bank_mask:0xf
    v_and_b32_dpp v47, v31, v23 row_newbcast:13 row_mask:0xf bank_mask:0xf
    s_waitcnt vmcnt(3)
    s_cbranch_vccnz L_sh_109
    s_waitcnt vmcnt(2)
L_sh_109:
    s_mov_b32 s56, 983040
    buffer_load_dwordx4 v[104:107], v15, s[36:39], s56 offen nt
    s_waitcnt vmcnt(3)
    s_cbranch_vccnz L_sh_110
    s_waitcnt vmcnt(2)
L_sh_110:
    buffer_load_dwordx4 v[108:111], v15, s[36:39], s56 offen offset:1024 nt
    s_waitcnt vmcnt(3)
    s_cbranch_vccnz L_sh_111
    s_waitcnt vmcnt(2)
L_sh_111:
    buffer_load_dwordx4 v[112:115], v15, s[36:39], s56 offen offset:2048 nt
    s_waitcnt vmcnt(3)
    s_cbranch_vccnz L_sh_112
    s_waitcnt vmcnt(2)
L_sh_112:
    buffer_load_dwordx4 v[116:119], v15, s[36:39], s56 offen offset:3072 nt
    ds_read_b32 v55, v14 offset:30976
    s_nop 1
    v_mfma_f32_16x16x32_bf16 v[24:27], v[32:35], v[88:91], v[24:27]
    v_mfma_f32_16x16x32_bf16 v[24:27], v[36:39], v[92:95], v[24:27]
    v_mfma_f32_16x16x32_bf16 v[24:27], v[40:43], v[96:99], v[24:27]
    v_mfma_f32_16x16x32_bf16 v[24:27], v[44:47], v[100:103], v[24:27]
    s_waitcnt lgkmcnt(0)
    v_readfirstlane_b32 s57, v55
    s_nop 3
    s_cmp_lg_u32 s57, 0
    s_cselect_b64 vcc, -1, 0
    v_and_b32_dpp v32, v31, v20 row_newbcast:3 row_mask:0xf bank_mask:0xf
    v_and_b32_dpp v33, v31, v21 row_newbcast:3 row_mask:0xf bank_mask:0xf
    v_and_b32_dpp v34, v31, v22 row_newbcast:3 row_mask:0xf bank_mask:0xf
    v_and_b32_dpp v35, v31, v23 row_newbcast:3 row_mask:0xf bank_mask:0xf
    v_and_b32_dpp v36, v31, v20 row_newbcast:11 row_mask:0xf bank_mask:0xf
    v_and_b32_dpp v37, v31, v21 row_newbcast:11 row_mask:0xf bank_mask:0xf
    v_and_b32_dpp v38, v31, v22 row_newbcast:11 row_mask:0xf bank_mask:0xf
    v_and_b32_dpp v39, v31, v23 row_newbcast:11 row_mask:0xf bank_mask:0xf
    v_and_b32_dpp v40, v31, v20 row_newbcast:7 row_mask:0xf bank_mask:0xf
    v_and_b32_dpp v41, v31, v21 row_newbcast:7 row_mask:0xf bank_mask:0xf
    v_and_b32_dpp v42, v31, v22 row_newbcast:7 row_mask:0xf bank_mask:0xf
    v_and_b32_dpp v43, v31, v23 row_newbcast:7 row_mask:0xf bank_mask:0xf
    v_and_b32_dpp v44, v31, v20 row_newbcast:15 row_mask:0xf bank_mask:0xf
    v_and_b32_dpp v45, v31, v21 row_newbcast:15 row_mask:0xf bank_mask:0xf
    v_and_b32_dpp v46, v31, v22 row_newbcast:15 row_mask:0xf bank_mask:0xf
    v_and_b32_dpp v47, v31, v23 row_newbcast:15 row_mask:0xf bank_mask:0xf
    s_waitcnt vmcnt(3)
    s_waitcnt vmcnt(2)
    s_waitcnt vmcnt(1)
    s_waitcnt vmcnt(0)
    s_nop 1
    v_mfma_f32_16x16x32_bf16 v[24:27], v[32:35], v[104:107], v[24:27]
    v_mfma_f32_16x16x32_bf16 v[24:27], v[36:39], v[108:111], v[24:27]
    v_mfma_f32_16x16x32_bf16 v[24:27], v[40:43], v[112:115], v[24:27]
    v_mfma_f32_16x16x32_bf16 v[24:27], v[44:47], v[116:119], v[24:27]
    s_nop 7
    s_mov_b32 exec_hi, 0
    ds_write_b128 v11, v[24:27] offset:6400
    s_mov_b64 exec, -1
    v_lshrrev_b32 v12, 2, v2
    v_and_b32 v13, 3, v2
    v_lshl_add_u32 v13, v13, 2, v3
    s_lshl_b32 s57, s30, 4
    v_add_u32 v13, s57, v13
    v_lshlrev_b32 v13, 2, v13
    v_lshl_add_u32 v13, v12, 10, v13
    v_mov_b32 v52, 0
    s_waitcnt lgkmcnt(0)
    s_barrier
    ds_read2st64_b32 v[48:49], v13 offset0:25 offset1:27
    ds_read_b32 v50, v52 offset:0
    s_mul_i32 s57, s30, 2560
    v_add_u32 v12, s57, v10
    s_waitcnt lgkmcnt(0)
    v_add_f32 v48, v48, v49
    s_nop 1
    v_add_f32_dpp v48, v48, v48 row_ror:4 row_mask:0xf bank_mask:0xf
    s_nop 1
    v_add_f32_dpp v48, v48, v48 row_ror:8 row_mask:0xf bank_mask:0xf
    v_mul_f32 v48, v48, v50
    v_cvt_pk_bf16_f32 v48, v48, v48
    s_nop 1
    v_and_b32_dpp v32, v48, v20 row_newbcast:0 row_mask:0xf bank_mask:0xf
    v_and_b32_dpp v33, v48, v21 row_newbcast:0 row_mask:0xf bank_mask:0xf
    v_and_b32_dpp v34, v48, v22 row_newbcast:0 row_mask:0xf bank_mask:0xf
    v_and_b32_dpp v35, v48, v23 row_newbcast:0 row_mask:0xf bank_mask:0xf
    v_and_b32_dpp v36, v48, v20 row_newbcast:1 row_mask:0xf bank_mask:0xf
    v_and_b32_dpp v37, v48, v21 row_newbcast:1 row_mask:0xf bank_mask:0xf
    v_and_b32_dpp v38, v48, v22 row_newbcast:1 row_mask:0xf bank_mask:0xf
    v_and_b32_dpp v39, v48, v23 row_newbcast:1 row_mask:0xf bank_mask:0xf
    v_and_b32_dpp v40, v48, v20 row_newbcast:2 row_mask:0xf bank_mask:0xf
    v_and_b32_dpp v41, v48, v21 row_newbcast:2 row_mask:0xf bank_mask:0xf
    v_and_b32_dpp v42, v48, v22 row_newbcast:2 row_mask:0xf bank_mask:0xf
    v_and_b32_dpp v43, v48, v23 row_newbcast:2 row_mask:0xf bank_mask:0xf
    v_and_b32_dpp v44, v48, v20 row_newbcast:3 row_mask:0xf bank_mask:0xf
    v_and_b32_dpp v45, v48, v21 row_newbcast:3 row_mask:0xf bank_mask:0xf
    v_and_b32_dpp v46, v48, v22 row_newbcast:3 row_mask:0xf bank_mask:0xf
    v_and_b32_dpp v47, v48, v23 row_newbcast:3 row_mask:0xf bank_mask:0xf
    s_nop 1
    v_mfma_f32_16x16x32_bf16 v[56:59], v[32:35], v[168:171], 0
    v_mfma_f32_16x16x32_bf16 v[60:63], v[32:35], v[172:175], 0
    v_mfma_f32_16x16x32_bf16 v[64:67], v[32:35], v[176:179], 0
    v_mfma_f32_16x16x32_bf16 v[68:71], v[32:35], v[180:183], 0
    v_mfma_f32_16x16x32_bf16 v[72:75], v[32:35], v[184:187], 0
    v_mfma_f32_16x16x32_bf16 v[56:59], v[36:39], v[188:191], v[56:59]
    v_mfma_f32_16x16x32_bf16 v[60:63], v[36:39], v[192:195], v[60:63]
    v_mfma_f32_16x16x32_bf16 v[64:67], v[36:39], v[196:199], v[64:67]
    v_mfma_f32_16x16x32_bf16 v[68:71], v[36:39], v[200:203], v[68:71]
    v_mfma_f32_16x16x32_bf16 v[72:75], v[36:39], v[204:207], v[72:75]
    v_mfma_f32_16x16x32_bf16 v[56:59], v[40:43], v[208:211], v[56:59]
    v_mfma_f32_16x16x32_bf16 v[60:63], v[40:43], v[212:215], v[60:63]
    v_mfma_f32_16x16x32_bf16 v[64:67], v[40:43], v[216:219], v[64:67]
    v_mfma_f32_16x16x32_bf16 v[68:71], v[40:43], v[220:223], v[68:71]
    v_mfma_f32_16x16x32_bf16 v[72:75], v[40:43], v[224:227], v[72:75]
    v_mfma_f32_16x16x32_bf16 v[56:59], v[44:47], v[228:231], v[56:59]
    v_mfma_f32_16x16x32_bf16 v[60:63], v[44:47], v[232:235], v[60:63]
    v_mfma_f32_16x16x32_bf16 v[64:67], v[44:47], v[236:239], v[64:67]
    v_mfma_f32_16x16x32_bf16 v[68:71], v[44:47], v[240:243], v[68:71]
    v_mfma_f32_16x16x32_bf16 v[72:75], v[44:47], v[244:247], v[72:75]
    s_mov_b32 exec_hi, 0
    s_lshl_b32 s59, s69, 12
    s_mul_i32 s60, s28, 2560
    s_mul_i32 s58, s26, 1280
    s_add_u32 s60, s60, s58
    ds_write_b128 v12, v[56:59] offset:10496
    ds_write_b128 v12, v[60:63] offset:11008
    ds_write_b128 v12, v[64:67] offset:11520
    ds_write_b128 v12, v[68:71] offset:12032
    ds_write_b128 v12, v[72:75] offset:12544
    s_mov_b64 exec, -1
    s_waitcnt lgkmcnt(0)
    s_barrier
    ds_read2st64_b32 v[168:169], v16 offset0:41 offset1:51
    ds_read2st64_b32 v[170:171], v16 offset0:61 offset1:71
    ds_read2st64_b32 v[172:173], v16 offset0:81 offset1:91
    ds_read2st64_b32 v[174:175], v16 offset0:101 offset1:111
    ds_read2st64_b32 v[176:177], v17 offset0:41 offset1:51
    ds_read2st64_b32 v[178:179], v17 offset0:61 offset1:71
    ds_read2st64_b32 v[180:181], v17 offset0:81 offset1:91
    ds_read2st64_b32 v[182:183], v17 offset0:101 offset1:111
    s_waitcnt lgkmcnt(4)
    v_add_f32 v168, v168, v169
    v_add_f32 v170, v170, v171
    v_add_f32 v172, v172, v173
    v_add_f32 v174, v174, v175
    v_add_f32 v168, v168, v170
    v_add_f32 v172, v172, v174
    v_add_f32 v168, v168, v172
    v_cndmask_b32 v168, v18, v168, s[64:65]
    v_mov_b32 v169, v168
    buffer_atomic_add_f32 v169, v19, s[52:55], s59 offen offset:0 sc0
    s_waitcnt lgkmcnt(0)
    v_add_f32 v176, v176, v177
    v_add_f32 v178, v178, v179
    v_add_f32 v180, v180, v181
    v_add_f32 v182, v182, v183
    v_add_f32 v176, v176, v178
    v_add_f32 v180, v180, v182
    v_add_f32 v176, v176, v180
    v_cndmask_b32 v176, v18, v176, s[64:65]
    v_mov_b32 v177, v176
    buffer_atomic_add_f32 v177, v19, s[52:55], s59 offen offset:256 sc0
    s_waitcnt vmcnt(0)
    v_mov_b32_dpp v170, v169 row_newbcast:0 row_mask:0xf bank_mask:0xf
    v_add_f32 v168, v168, v169
    v_cmp_eq_f32 vcc, 0x427c0000, v170
    v_cvt_pk_bf16_f32 v168, v168, v168
    v_lshrrev_b32 v171, 1, v16
    s_and_b64 exec, vcc, s[64:65]
    s_cbranch_execz L_nst_113
    buffer_store_short v168, v171, s[76:79], s60 offen
L_nst_113:
    s_mov_b64 exec, -1
    v_mov_b32_dpp v178, v177 row_newbcast:0 row_mask:0xf bank_mask:0xf
    v_add_f32 v176, v176, v177
    v_cmp_eq_f32 vcc, 0x427c0000, v178
    v_cvt_pk_bf16_f32 v176, v176, v176
    v_lshrrev_b32 v179, 1, v17
    s_and_b64 exec, vcc, s[64:65]
    s_cbranch_execz L_nst_114
    buffer_store_short v176, v179, s[76:79], s60 offen
L_nst_114:
    s_mov_b64 exec, -1
L_end:
L_exit:
    s_endpgm
.section .rodata,"a"
.p2align 6
.amdhsa_kernel concat_heads__gqa_block_cached__gqa_block_cached__decode_kernel
  .amdhsa_next_free_vgpr 248
  .amdhsa_next_free_sgpr 80
  .amdhsa_accum_offset 248
  .amdhsa_group_segment_fixed_size 0
  .amdhsa_kernarg_size 104
  .amdhsa_user_sgpr_count 2
  .amdhsa_user_sgpr_kernarg_segment_ptr 1
  .amdhsa_system_sgpr_workgroup_id_x 1
  .amdhsa_float_denorm_mode_32 3
.end_amdhsa_kernel
```
